```python
import torch

def _softmax(x, axis=-1):
    return torch.softmax(x, dim=axis)
def _gelu(x):
    return torch.nn.functional.gelu(x, approximate="tanh")
def _silu(x):
    return torch.nn.functional.silu(x)
def _sigmoid(x):
    return torch.sigmoid(x)
def _layernorm(x, axis=-1, eps=1e-5):
    m = x.mean(dim=axis, keepdim=True)
    v = x.var(dim=axis, keepdim=True, unbiased=False)
    return (x - m) / torch.sqrt(v + eps)
def _scatter_add(tgt, idx, src, axis=0):
    return tgt.clone().index_add_(axis, idx, src)
def _segment_sum(src, seg, n):
    out = torch.zeros((n,) + src.shape[1:], dtype=src.dtype)
    return out.index_add_(0, seg, src)
def _pad(x, pw):
    flat = tuple(v for pair in reversed(pw) for v in pair)
    return torch.nn.functional.pad(x, flat)

kernel_name = 'parallel_sum__linear_kernel_hedgehog__dense_activation_squared_relu__prompt'

def setup_inputs():

    _w = (lambda a: (lambda t: t.to(torch.bfloat16) if t.is_floating_point() else t)(torch.as_tensor(a)))
    def _A_setup():
        B, S, D, H = 1, 2048, 640, 32
        Dh = D // H
        return {
            "x": _w((lambda *s: torch.randn(*s, dtype=torch.bfloat16) * 0.05)(B, S, D)),
            "wqkv": _w((lambda *s: torch.randn(*s, dtype=torch.bfloat16) * 0.8)(D, 3 * D)),
            "w_phi": _w((lambda *s: torch.randn(*s, dtype=torch.bfloat16) * 0.8)(H, Dh, Dh) * (Dh ** -0.5)),
            "wo": _w((lambda *s: torch.randn(*s, dtype=torch.bfloat16) * 0.2)(D, D)),
        }
    _A_in = _A_setup()

    def _B_setup():
        B, S, D, F = 1, 2048, 640, 1536
        return {
            "x": _w((lambda *s: torch.randn(*s, dtype=torch.bfloat16) * 0.05)(B, S, D)),
            "w1": _w((lambda *s: torch.randn(*s, dtype=torch.bfloat16) * 0.05)(D, F)),
            "b1": _w((lambda *s: torch.randn(*s, dtype=torch.bfloat16) * 0.8)(F)),
            "w2": _w((lambda *s: torch.randn(*s, dtype=torch.bfloat16) * 0.05)(F, D)),
            "b2": _w((lambda *s: torch.randn(*s, dtype=torch.bfloat16) * 3.2)(D)),
        }
    _B_in = _B_setup()

    return {
        "A_x": _A_in["x"],
        "A_wqkv": _A_in["wqkv"],
        "A_w_phi": _A_in["w_phi"],
        "A_wo": _A_in["wo"],
        "B_x": _B_in["x"],
        "B_w1": _B_in["w1"],
        "B_b1": _B_in["b1"],
        "B_w2": _B_in["w2"],
        "B_b2": _B_in["b2"],
    }

def reference(A_x, A_wqkv, A_w_phi, A_wo, B_x, B_w1, B_b1, B_w2, B_b2):
    def _A_ref(x, wqkv, w_phi, wo):
        B, S, D = x.shape
        H = 32; Dh = D // H
        qkv = (lambda x, *d: x.permute(*d))((x @ wqkv).reshape(B, S, 3, H, Dh), 2, 0, 3, 1, 4)
        q, k, v = qkv[0], qkv[1], qkv[2]
        pq = torch.einsum("bhsd,hdf->bhsf", q, w_phi)
        pk = torch.einsum("bhsd,hdf->bhsf", k, w_phi)
        phi_q = torch.concatenate([_softmax(pq, axis=-1), _softmax(-pq, axis=-1)], axis=-1)
        phi_k = torch.concatenate([_softmax(pk, axis=-1), _softmax(-pk, axis=-1)], axis=-1)
        kv = torch.einsum("bhsf,bhsd->bhfd", phi_k, v)
        z  = torch.einsum("bhsf->bhf", phi_k)
        num = torch.einsum("bhqf,bhfd->bhqd", phi_q, kv)
        den = torch.einsum("bhqf,bhf->bhq", phi_q, z)[..., None] + 1e-6
        o = num / den
        return (lambda x, *d: x.permute(*d))(o, 0, 2, 1, 3).reshape(B, S, D) @ wo

    def _B_ref(x, w1, b1, w2, b2):
        h = torch.einsum("bsd,df->bsf", x, w1) + b1
        zero = torch.zeros_like(h)
        r = torch.where(h > zero, h, zero)
        h = r * r
        out = torch.einsum("bsf,fd->bsd", h, w2) + b2
        return out

    x = A_x
    xn = _layernorm(x, axis=-1)
    return x + _A_ref(xn, A_wqkv, A_w_phi, A_wo) + _B_ref(xn, B_w1, B_b1, B_w2, B_b2)
```

```asm
; @launch grid=(256,1,1) block=(256,1,1) lds=163840
.amdgcn_target "amdgcn-amd-amdhsa--gfx950"
.text
.globl parallel_sum__linear_kernel_hedgehog__dense_activation_squared_relu__prompt_kernel
.p2align 8
.type parallel_sum__linear_kernel_hedgehog__dense_activation_squared_relu__prompt_kernel,@function
parallel_sum__linear_kernel_hedgehog__dense_activation_squared_relu__prompt_kernel:
    s_cmp_ge_u32 s2, 256
    s_cbranch_scc1 L_end
    s_getpc_b64 s[62:63]
L_pc:
    v_lshlrev_b32 v1, 7, v0
    v_min_u32 v1, L_last-L_pc-4, v1
    global_load_dword v255, v1, s[62:63]
    s_load_dwordx16 s[16:31], s[0:1], 0
    s_load_dwordx8 s[32:39], s[0:1], 64
    v_and_b32 v1, 63, v0
    v_lshrrev_b32 v6, 6, v0
    v_lshlrev_b32 v2, 4, v1
    v_readfirstlane_b32 s54, v6
    v_lshrrev_b32 v8, 4, v1
    v_and_b32 v9, 15, v1
    v_mov_b32 v7, 0x80000000
    s_and_b32 s61, s2, 3
    s_bfe_u32 s62, s2, 0x20003
    s_lshl_b32 s61, s61, 2
    s_add_u32 s52, s61, s62
    s_bfe_u32 s63, s2, 0x10002
    s_lshr_b32 s64, s2, 5
    s_lshl_b32 s63, s63, 3
    s_add_u32 s53, s63, s64
    s_lshl_b32 s60, s54, 4
    s_add_u32 s60, s60, s52
    s_mul_i32 s61, s64, 5
    s_lshr_b32 s61, s61, 2
    s_mul_i32 s62, s62, 5
    s_add_u32 s62, s62, 1
    s_lshr_b32 s62, s62, 1
    s_add_u32 s61, s61, s62
    s_sub_u32 s62, s61, 10
    s_cmp_ge_u32 s61, 10
    s_cselect_b32 s61, s62, s61
    s_lshl_b32 s69, s61, 12
    v_mul_u32_u24 v6, 52, v9
    v_lshrrev_b32 v6, 8, v6
    v_mul_u32_u24 v10, 1200, v6
    v_lshl_add_u32 v10, v9, 4, v10
    v_add_u32 v10, 1280, v10
    v_cmp_eq_u32 vcc, 2, v6
    v_subrev_u32 v11, 3840, v10
    v_mul_u32_u24 v6, 3840, v8
    v_cndmask_b32 v10, v10, v11, vcc
    v_cmp_gt_u32 vcc, 15, v9
    v_add_u32 v10, v10, v6
    v_mul_u32_u24 v47, 3072, v8
    v_cndmask_b32 v10, v7, v10, vcc
    v_cmp_gt_u32 vcc, 12, v9
    v_lshl_add_u32 v47, v9, 4, v47
    v_lshrrev_b32 v6, 3, v1
    v_cndmask_b32 v47, v7, v47, vcc
    s_mul_i32 s65, s60, 61440
    s_mul_i32 s66, s53, 80
    s_add_u32 s65, s65, s66
    s_mul_i32 s67, s60, 49152
    s_mul_i32 s66, s53, 192
    s_add_u32 s67, s67, s66
    s_lshl_b32 s68, s54, 13
    s_add_u32 s68, s68, 114688
    s_mov_b32 m0, s68
    s_lshl_b32 s61, s52, 7
    s_lshl_b32 s62, s54, 5
    s_add_u32 s61, s61, s62
    s_mul_i32 s61, s61, 1280
    v_mul_u32_u24 v6, 1280, v6
    v_and_b32 v12, 7, v1
    v_xor_b32 v12, v12, v8
    v_lshlrev_b32 v12, 4, v12
    v_add3_u32 v16, v6, v12, s61
    v_xor_b32 v17, 64, v16
    v_add_u32 v17, 10240, v17
    v_add_u32 v18, 20480, v16
    v_add_u32 v19, 20480, v17
    s_waitcnt lgkmcnt(0)
    s_mov_b32 s70, s68
    s_cmp_ge_u32 s60, 40
    s_cbranch_scc1 L_roleW
    s_mov_b32 s12, s18
    s_mov_b32 s13, s19
    s_mov_b32 s14, 2457600
    s_mov_b32 s15, 0x20000
    buffer_load_dwordx4 v10, s[12:15], s65 offen offset:0 lds
    s_add_u32 s65, s65, 14336
    buffer_load_dwordx4 v10, s[12:15], s65 offen offset:1024 lds
    s_add_u32 s65, s65, 14336
    buffer_load_dwordx4 v10, s[12:15], s65 offen offset:2048 lds
    s_add_u32 s65, s65, 14336
    buffer_load_dwordx4 v10, s[12:15], s65 offen offset:3072 lds
    s_mov_b32 s8, s16
    s_mov_b32 s9, s17
    s_mov_b32 s10, 2621440
    s_mov_b32 s11, 0x20000
    s_mov_b32 s12, s26
    s_mov_b32 s13, s27
    s_mov_b32 s14, 1966080
    s_mov_b32 s15, 0x20000
    s_mov_b32 s44, s20
    s_mov_b32 s45, s21
    s_mov_b32 s46, 25600
    s_mov_b32 s47, 0x20000
    s_mov_b32 s48, s28
    s_mov_b32 s49, s29
    s_mov_b32 s50, 3072
    s_mov_b32 s51, 0x20000
    s_mov_b32 s16, s69
    s_lshl_b32 s26, s54, 10
    s_add_u32 m0, s26, 65536
    s_lshr_b32 s61, s16, 5
    buffer_load_dwordx4 v16, s[8:11], s61 offen lds
    s_add_u32 m0, s26, 69632
    s_nop 0
    buffer_load_dwordx4 v17, s[8:11], s61 offen lds
    s_add_u32 m0, s26, 73728
    s_nop 0
    buffer_load_dwordx4 v18, s[8:11], s61 offen lds
    s_add_u32 m0, s26, 77824
    s_nop 0
    buffer_load_dwordx4 v19, s[8:11], s61 offen lds
    s_mov_b32 s36, s67
    s_mov_b32 s4, s38
    s_mov_b32 s5, s39
    s_mov_b32 s6, 268435456
    s_mov_b32 s7, 0x20000
    s_load_dwordx2 s[58:59], s[38:39], 0
    s_add_u32 s17, s16, 4096
    s_cmp_eq_u32 s17, 40960
    s_cselect_b32 s17, 0, s17
    s_add_u32 s18, s17, 4096
    s_cmp_eq_u32 s18, 40960
    s_cselect_b32 s18, 0, s18
    s_add_u32 s19, s18, 4096
    s_cmp_eq_u32 s19, 40960
    s_cselect_b32 s19, 0, s19
    v_lshrrev_b32 v11, 5, v1
    v_lshrrev_b32 v36, 2, v9
    v_and_b32 v37, 3, v9
    s_mul_i32 s27, s53, 286720
    s_add_u32 s27, s27, 524288
    v_lshl_add_u32 v38, v11, 3, v36
    v_lshlrev_b32 v38, 8, v38
    v_add_u32 v38, s70, v38
    v_and_b32 v39, 1, v8
    v_lshrrev_b32 v6, 1, v37
    v_lshl_add_u32 v39, v39, 1, v6
    v_and_b32 v40, 1, v37
    v_mad_u32_u24 v41, v40, 40, v38
    v_add_u32 v6, 0, v39
    v_mul_u32_u24 v46, 52, v6
    v_lshrrev_b32 v46, 8, v46
    v_lshl_add_u32 v6, v6, 3, v41
    v_mad_u32_u24 v52, v46, 40, v6
    v_add_u32 v6, 4, v39
    v_mul_u32_u24 v46, 52, v6
    v_lshrrev_b32 v46, 8, v46
    v_lshl_add_u32 v6, v6, 3, v41
    v_mad_u32_u24 v53, v46, 40, v6
    v_add_u32 v6, 8, v39
    v_mul_u32_u24 v46, 52, v6
    v_lshrrev_b32 v46, 8, v46
    v_lshl_add_u32 v6, v6, 3, v41
    v_mad_u32_u24 v54, v46, 40, v6
    v_add_u32 v6, 12, v39
    v_mul_u32_u24 v46, 52, v6
    v_lshrrev_b32 v46, 8, v46
    v_lshl_add_u32 v6, v6, 3, v41
    v_mad_u32_u24 v55, v46, 40, v6
    v_lshl_add_u32 v46, v40, 5, v38
    v_lshl_add_u32 v46, v39, 3, v46
    s_lshl_b32 s28, s60, 10
    s_add_u32 s28, s28, s27
    v_mov_b32 v12, 0
    v_mov_b32 v13, 0
    v_mov_b32 v14, 0
    v_mov_b32 v15, 0
    s_waitcnt lgkmcnt(0)
    s_mul_i32 s58, s58, 1664525
    s_add_u32 s58, s58, 1013904223
    s_mul_i32 s59, s59, 22695477
    s_add_u32 s59, s59, 1
    v_mov_b32 v40, s58
    v_mov_b32 v41, s59
    v_accvgpr_write_b32 a252, v40
    v_accvgpr_write_b32 a253, v41
    s_waitcnt vmcnt(4)
    ds_read_b64_tr_b16 v[80:81], v52 offset:0
    ds_read_b64_tr_b16 v[82:83], v52 offset:1024
    ds_read_b64_tr_b16 v[84:85], v53 offset:0
    ds_read_b64_tr_b16 v[86:87], v53 offset:1024
    ds_read_b64_tr_b16 v[88:89], v54 offset:0
    ds_read_b64_tr_b16 v[90:91], v54 offset:1024
    ds_read_b64_tr_b16 a[92:93], v55 offset:0
    ds_read_b64_tr_b16 a[94:95], v55 offset:1024
    s_waitcnt lgkmcnt(6)
    buffer_store_dwordx4 v[80:83], v2, s[4:7], s28 offen sc1
    s_add_u32 s28, s28, 40960
    s_waitcnt lgkmcnt(4)
    buffer_store_dwordx4 v[84:87], v2, s[4:7], s28 offen sc1
    s_add_u32 s28, s28, 40960
    s_waitcnt lgkmcnt(2)
    buffer_store_dwordx4 v[88:91], v2, s[4:7], s28 offen sc1
    s_add_u32 s28, s28, 40960
    s_add_u32 m0, s26, 81920
    s_lshr_b32 s61, s17, 5
    buffer_load_dwordx4 v16, s[8:11], s61 offen lds
    s_add_u32 m0, s26, 86016
    s_nop 0
    buffer_load_dwordx4 v17, s[8:11], s61 offen lds
    s_add_u32 m0, s26, 90112
    s_nop 0
    buffer_load_dwordx4 v18, s[8:11], s61 offen lds
    s_add_u32 m0, s26, 94208
    s_nop 0
    buffer_load_dwordx4 v19, s[8:11], s61 offen lds
    s_add_u32 m0, s26, 98304
    s_lshr_b32 s61, s18, 5
    buffer_load_dwordx4 v16, s[8:11], s61 offen lds
    s_add_u32 m0, s26, 102400
    s_nop 0
    buffer_load_dwordx4 v17, s[8:11], s61 offen lds
    s_add_u32 m0, s26, 106496
    s_nop 0
    buffer_load_dwordx4 v18, s[8:11], s61 offen lds
    s_add_u32 m0, s26, 110592
    s_nop 0
    buffer_load_dwordx4 v19, s[8:11], s61 offen lds
    s_cmp_lg_u32 s54, 0
    s_cbranch_scc1 L_j1
    s_mul_i32 s62, s53, 1600
    s_mov_b32 m0, 155648
    v_cmp_gt_u32 vcc, 36, v1
    s_nop 1
    v_cndmask_b32 v6, v7, v2, vcc
    buffer_load_dwordx4 v2, s[44:47], s62 offen lds
    buffer_load_dwordx4 v6, s[44:47], s62 offen offset:1024 lds
    s_branch L_j4
L_j1:
    s_cmp_lg_u32 s54, 1
    s_cbranch_scc1 L_j4
    s_mul_i32 s62, s53, 192
    v_lshlrev_b32 v6, 2, v1
    v_cmp_gt_u32 vcc, 48, v1
    s_nop 1
    v_cndmask_b32 v6, v7, v6, vcc
    buffer_load_dword v32, v6, s[48:51], s62 offen
    v_add_u32 v6, 157696, v2
    ds_write_b128 v6, v[12:15]
    ds_write_b128 v6, v[12:15] offset:1024
    ds_write_b128 v6, v[12:15] offset:2048
L_j4:
    s_mov_b32 s40, s34
    s_mov_b32 s41, s35
    s_mov_b32 s42, 2621440
    s_mov_b32 s43, 0x20000
    s_add_u32 s20, s19, 4096
    s_cmp_eq_u32 s20, 40960
    s_cselect_b32 s20, 0, s20
    s_add_u32 s21, s20, 4096
    s_cmp_eq_u32 s21, 40960
    s_cselect_b32 s21, 0, s21
    s_add_u32 s22, s21, 4096
    s_cmp_eq_u32 s22, 40960
    s_cselect_b32 s22, 0, s22
    s_add_u32 s23, s22, 4096
    s_cmp_eq_u32 s23, 40960
    s_cselect_b32 s23, 0, s23
    s_add_u32 s24, s23, 4096
    s_cmp_eq_u32 s24, 40960
    s_cselect_b32 s24, 0, s24
    s_add_u32 s25, s24, 4096
    s_cmp_eq_u32 s25, 40960
    s_cselect_b32 s25, 0, s25
    s_mov_b32 s44, s32
    s_mov_b32 s45, s33
    s_mov_b32 s46, 1280
    s_mov_b32 s47, 0x20000
    s_and_b32 s56, s53, 7
    s_lshr_b32 s65, s53, 3
    s_lshl_b32 s66, s52, 1
    s_add_u32 s55, s66, s65
    s_mov_b32 s57, 400000
    s_mul_i32 s80, s56, 160
    v_lshl_add_u32 v6, v1, 2, s80
    s_mov_b32 m0, 161280
    s_nop 0
    buffer_load_dword v6, s[44:47], 0 offen lds
    s_lshl_b32 s79, s55, 6
    s_lshl_b32 s66, s54, 4
    s_add_u32 s79, s79, s66
    s_mul_i32 s79, s79, 1280
    s_add_u32 s79, s79, s80
    v_lshlrev_b32 v61, 1, v8
    v_sub_u32 v61, v9, v61
    v_cmp_gt_u32 vcc, 10, v61
    v_mul_u32_u24 v60, 1280, v8
    v_lshl_add_u32 v60, v61, 4, v60
    v_cndmask_b32 v60, v7, v60, vcc
    v_and_b32 v10, 31, v1
    v_bfe_u32 v6, v10, 1, 3
    v_xor_b32 v6, v6, v11
    v_lshlrev_b32 v6, 4, v6
    v_and_b32 v20, 7, v10
    v_lshl_add_u32 v6, v20, 7, v6
    v_lshrrev_b32 v20, 3, v10
    v_lshl_add_u32 v6, v20, 12, v6
    v_add_u32 v20, s26, v6
    v_xor_b32 v21, 32, v20
    v_xor_b32 v22, 64, v20
    v_xor_b32 v23, 0x60, v20
    v_add_u32 v24, 0x10000, v20
    v_add_u32 v25, 0x10000, v21
    v_add_u32 v26, 0x10000, v22
    v_add_u32 v27, 0x10000, v23
    v_lshrrev_b32 v6, 2, v9
    v_xor_b32 v6, v6, v8
    v_and_b32 v6, 1, v6
    v_cmp_eq_u32 vcc, 0, v6
    v_mov_b32 v6, 0x3f803f80
    s_nop 0
    v_cndmask_b32 v28, 0, v6, vcc
    v_mov_b32 v29, v28
    v_mov_b32 v30, v28
    v_mov_b32 v31, v28
    s_lshl_b32 s34, s53, 13
    s_and_b32 s62, s60, 3
    s_lshl_b32 s62, s62, 11
    s_add_u32 s34, s34, s62
    s_lshr_b32 s62, s60, 2
    s_lshl_b32 s62, s62, 7
    s_add_u32 s34, s34, s62
    s_add_u32 s35, s34, 131072
    s_add_u32 s34, s34, 262144
    s_mov_b32 s69, 8
    s_mov_b32 s29, 40960
    v_mov_b32 v62, v7
    v_mov_b32 v63, v7
    s_add_u32 s61, s27, s26
    v_add_u32 v3, s61, v2
    v_and_b32 v6, 1, v8
    v_lshlrev_b32 v6, 10, v6
    v_lshl_add_u32 v6, v11, 9, v6
    v_lshl_add_u32 v6, v9, 4, v6
    v_lshrrev_b32 v42, 2, v10
    v_mul_u32_u24 v42, 16, v42
    s_mul_i32 s61, s54, 5248
    s_add_u32 s61, s61, 65536
    s_mul_i32 s62, s54, 3200
    s_add_u32 s62, s62, 88064
    v_mul_u32_u24 v40, 160, v10
    v_mul_u32_u24 v41, 80, v11
    v_add3_u32 v40, v40, v41, s61
    v_add_u32 v40, v40, v42
    v_accvgpr_write_b32 a80, v40
    v_mul_u32_u24 v40, 96, v10
    v_mul_u32_u24 v41, 48, v11
    v_add3_u32 v40, v40, v41, s62
    v_add_u32 v40, v40, v42
    v_accvgpr_write_b32 a81, v40
    s_lshr_b32 s61, s54, 1
    s_mul_i32 s62, s61, 48
    s_mul_i32 s61, s61, 80
    s_add_u32 s61, s61, 65536
    s_and_b32 s63, s54, 1
    s_lshl_b32 s64, s63, 5
    s_add_u32 s62, s62, s64
    s_add_u32 s62, s62, 88064
    v_lshl_add_u32 v42, v8, 2, v36
    v_mul_u32_u24 v40, 160, v42
    v_mad_u32_u24 v40, v8, 16, v40
    v_add_u32 v40, s61, v40
    v_lshl_add_u32 v41, v37, 3, v40
    v_accvgpr_write_b32 a83, v41
    v_mul_u32_u24 v40, 96, v42
    v_mad_u32_u24 v40, v8, 16, v40
    v_add_u32 v40, s62, v40
    v_lshl_add_u32 v41, v37, 3, v40
    v_accvgpr_write_b32 a84, v41
    v_and_b32 v40, 1, v8
    v_lshrrev_b32 v41, 1, v37
    v_lshl_add_u32 v40, v40, 1, v41
    v_lshlrev_b32 v40, 3, v40
    v_mad_u32_u24 v40, v36, 40, v40
    v_mul_u32_u24 v41, 800, v11
    v_add_u32 v40, v40, v41
    v_add_u32 v40, 155648, v40
    v_and_b32 v41, 1, v37
    v_cmp_eq_u32 vcc, v41, v11
    v_mov_b32 v41, 157696
    s_nop 0
    v_cndmask_b32 v40, v41, v40, vcc
    v_accvgpr_write_b32 a85, v40
    s_lshl_b32 s61, s54, 14
    s_lshl_b32 s64, s63, 8
    s_add_u32 s61, s61, s64
    s_lshr_b32 s64, 16, s63
    s_lshr_b32 s65, 0x100, s63
    v_lshlrev_b32 v42, 4, v9
    v_mad_u32_u24 v40, v8, s65, v42
    v_add_u32 v40, s61, v40
    v_cmp_gt_u32 vcc, s64, v9
    s_nop 1
    v_cndmask_b32 v40, v7, v40, vcc
    v_accvgpr_write_b32 a86, v40
    s_or_b32 s61, s54, 1
    s_lshl_b32 s61, s61, 14
    s_mul_i32 s65, s63, 768
    s_add_u32 s61, s61, s65
    v_lshl_add_u32 v40, v8, 3, v42
    v_add_u32 v40, s61, v40
    s_mov_b32 vcc_hi, 0
    s_nop 1
    v_cndmask_b32 v7, v7, v40, vcc
    s_lshl_b32 s31, s53, 16
    s_lshl_b32 s61, s52, 10
    s_add_u32 s31, s31, s61
    s_add_u32 s31, s31, 16842752
    v_subrev_u32 v40, 16, v1
    v_lshrrev_b32 v41, 3, v40
    v_min_u32 v41, 4, v41
    v_and_b32 v40, 7, v40
    v_min_u32 v40, 4, v40
    v_add_u32 v40, 16, v40
    v_cmp_gt_u32 vcc, 16, v1
    v_lshlrev_b32 v42, 3, v41
    s_nop 0
    v_cndmask_b32 v40, v40, v1, vcc
    v_cndmask_b32 v42, v42, 0, vcc
    v_add_u32 v42, v42, v40
    s_cmp_eq_u32 s63, 0
    s_cselect_b64 vcc, -1, 0
    v_cndmask_b32 v40, v40, v9, vcc
    v_cndmask_b32 v41, v41, v8, vcc
    v_cndmask_b32 v42, v42, v1, vcc
    s_lshr_b32 s61, s54, 1
    s_mul_i32 s61, s61, 2560
    s_add_u32 s61, s61, 102400
    v_lshlrev_b32 v40, 4, v40
    v_lshl_add_u32 v40, v41, 9, v40
    v_lshl_add_u32 v40, v42, 24, v40
    v_add_u32 v40, s61, v40
    v_accvgpr_write_b32 a254, v40
    v_bfe_u32 v40, v2, 7, 2
    v_and_b32 v41, 0x30, v2
    v_lshl_add_u32 v40, v40, 6, v41
    v_mul_u32_u24 v41, 2560, v11
    v_add_u32 v40, v40, v41
    v_add_u32 v40, 102400, v40
    v_bfe_u32 v41, v2, 6, 1
    v_cmp_eq_u32 vcc, v41, v11
    v_mov_b32 v41, 157696
    s_nop 0
    v_cndmask_b32 v40, v41, v40, vcc
    v_accvgpr_write_b32 a255, v40
    s_lshl_b32 s61, s52, 1
    s_lshr_b32 s62, s54, 1
    s_add_u32 s61, s61, s62
    s_mul_i32 s30, s61, 278528
    s_lshl_b32 s62, s63, 11
    s_add_u32 s30, s30, s62
    s_add_u32 s38, s30, 8192000
    s_lshr_b32 s62, s53, 2
    s_lshl_b32 s64, s62, 12
    s_add_u32 s38, s38, s64
    s_and_b32 s64, s53, 3
    s_lshl_b32 s65, s64, 8
    s_add_u32 s38, s38, s65
    s_lshl_b32 s65, s53, 12
    s_add_u32 s30, s30, s65
    s_add_u32 s30, s30, 7929856
    s_lshl_b32 s32, s52, 15
    s_lshl_b32 s62, s62, 13
    s_add_u32 s32, s32, s62
    s_lshl_b32 s64, s64, 9
    s_add_u32 s32, s32, s64
    s_lshl_b32 s63, s54, 7
    s_add_u32 s32, s32, s63
    s_add_u32 s32, s32, 18022400
    s_lshl_b32 s39, s53, 13
    s_add_u32 s39, s39, 17891328
    s_lshl_b32 s62, s60, 7
    s_add_u32 s33, s39, s62
    s_lshr_b32 s62, s54, 1
    s_lshl_b32 s62, s62, 12
    s_add_u32 s39, s39, s62
    v_bfe_u32 v40, v10, 3, 1
    v_bfe_u32 v41, v10, 1, 1
    v_lshl_add_u32 v40, v40, 1, v41
    v_lshrrev_b32 v41, 4, v10
    v_lshl_add_u32 v40, v41, 2, v40
    v_and_b32 v41, 1, v10
    v_lshlrev_b32 v41, 4, v41
    v_mov_b32 v42, 0x3f80
    v_lshlrev_b32 v41, v41, v42
    v_bfe_u32 v42, v10, 2, 1
    v_cmp_eq_u32 vcc, v42, v11
    s_nop 1
    v_cndmask_b32 v41, 0, v41, vcc
    v_cmp_eq_u32 vcc, 0, v40
    s_nop 1
    v_cndmask_b32 v42, 0, v41, vcc
    v_accvgpr_write_b32 a88, v42
    v_cmp_eq_u32 vcc, 1, v40
    s_nop 1
    v_cndmask_b32 v42, 0, v41, vcc
    v_accvgpr_write_b32 a89, v42
    v_cmp_eq_u32 vcc, 2, v40
    s_nop 1
    v_cndmask_b32 v42, 0, v41, vcc
    v_accvgpr_write_b32 a90, v42
    v_cmp_eq_u32 vcc, 3, v40
    s_nop 1
    v_cndmask_b32 v42, 0, v41, vcc
    v_accvgpr_write_b32 a91, v42
    v_cmp_eq_u32 vcc, 4, v40
    s_nop 1
    v_cndmask_b32 v42, 0, v41, vcc
    v_accvgpr_write_b32 a60, v42
    v_cmp_eq_u32 vcc, 5, v40
    s_nop 1
    v_cndmask_b32 v42, 0, v41, vcc
    v_accvgpr_write_b32 a61, v42
    v_cmp_eq_u32 vcc, 6, v40
    s_nop 1
    v_cndmask_b32 v42, 0, v41, vcc
    v_accvgpr_write_b32 a62, v42
    v_cmp_eq_u32 vcc, 7, v40
    s_nop 1
    v_cndmask_b32 v42, 0, v41, vcc
    v_accvgpr_write_b32 a63, v42
    s_add_u32 m0, s70, 4096
    s_nop 0
    buffer_load_dwordx4 v47, s[12:15], s36 offen offset:0 lds
    s_add_u32 s36, s36, 11264
    buffer_load_dwordx4 v47, s[12:15], s36 offen offset:1024 lds
    s_add_u32 s36, s36, 11264
    buffer_load_dwordx4 v47, s[12:15], s36 offen offset:2048 lds
    s_add_u32 s36, s36, 11264
    buffer_load_dwordx4 v47, s[12:15], s36 offen offset:3072 lds
    s_waitcnt vmcnt(16)
    ds_read_b128 v[96:99], v24 offset:0
    ds_read_b128 v[100:103], v25 offset:0
    ds_read_b128 v[104:107], v26 offset:0
    ds_read_b128 v[108:111], v27 offset:0
    s_waitcnt lgkmcnt(3)
    v_mfma_f32_16x16x32_bf16 v[48:51], v[28:31], v[96:99], 0
    s_waitcnt lgkmcnt(2)
    v_mfma_f32_16x16x32_bf16 v[48:51], v[28:31], v[100:103], v[48:51]
    s_waitcnt lgkmcnt(1)
    v_mfma_f32_16x16x32_bf16 v[48:51], v[28:31], v[104:107], v[48:51]
    s_waitcnt lgkmcnt(0)
    v_mfma_f32_16x16x32_bf16 v[48:51], v[28:31], v[108:111], v[48:51]
    s_waitcnt vmcnt(13)
    s_bfm_b64 exec, 8, 0
    buffer_store_dwordx4 a[252:255], v2, s[4:7], s35 offen sc1
    s_mov_b64 exec, -1
    s_waitcnt vmcnt(10)
    ds_read_b128 v[112:115], v24 offset:16384
    ds_read_b128 v[116:119], v25 offset:16384
    ds_read_b128 v[120:123], v26 offset:16384
    ds_read_b128 v[124:127], v27 offset:16384
    v_mfma_f32_32x32x16_bf16 v[64:79], v[96:99], v[96:99], 0
    s_add_u32 m0, s26, 0
    s_lshr_b32 s61, s19, 5
    buffer_load_dwordx4 v16, s[8:11], s61 offen lds
    v_mfma_f32_32x32x16_bf16 v[64:79], v[100:103], v[100:103], v[64:79]
    s_add_u32 m0, s26, 4096
    s_nop 0
    buffer_load_dwordx4 v17, s[8:11], s61 offen lds
    v_mfma_f32_32x32x16_bf16 v[64:79], v[104:107], v[104:107], v[64:79]
    s_add_u32 m0, s26, 8192
    s_nop 0
    buffer_load_dwordx4 v18, s[8:11], s61 offen lds
    v_mfma_f32_32x32x16_bf16 v[64:79], v[108:111], v[108:111], v[64:79]
    s_add_u32 m0, s26, 12288
    s_nop 0
    buffer_load_dwordx4 v19, s[8:11], s61 offen lds
    s_waitcnt lgkmcnt(3)
    v_mfma_f32_16x16x32_bf16 v[48:51], v[28:31], v[112:115], v[48:51]
    s_waitcnt lgkmcnt(2)
    v_mfma_f32_16x16x32_bf16 v[48:51], v[28:31], v[116:119], v[48:51]
    s_waitcnt lgkmcnt(1)
    v_mfma_f32_16x16x32_bf16 v[48:51], v[28:31], v[120:123], v[48:51]
    s_waitcnt lgkmcnt(0)
    v_mfma_f32_16x16x32_bf16 v[48:51], v[28:31], v[124:127], v[48:51]
    s_waitcnt vmcnt(10)
    ds_read_b128 v[128:131], v24 offset:32768
    ds_read_b128 v[132:135], v25 offset:32768
    ds_read_b128 v[136:139], v26 offset:32768
    ds_read_b128 v[140:143], v27 offset:32768
    v_mfma_f32_32x32x16_bf16 v[64:79], v[112:115], v[112:115], v[64:79]
    s_add_u32 m0, s26, 16384
    s_lshr_b32 s61, s20, 5
    buffer_load_dwordx4 v16, s[8:11], s61 offen lds
    v_mfma_f32_32x32x16_bf16 v[64:79], v[116:119], v[116:119], v[64:79]
    s_add_u32 m0, s26, 20480
    s_nop 0
    buffer_load_dwordx4 v17, s[8:11], s61 offen lds
    v_mfma_f32_32x32x16_bf16 v[64:79], v[120:123], v[120:123], v[64:79]
    s_add_u32 m0, s26, 24576
    s_nop 0
    buffer_load_dwordx4 v18, s[8:11], s61 offen lds
    v_mfma_f32_32x32x16_bf16 v[64:79], v[124:127], v[124:127], v[64:79]
    s_add_u32 m0, s26, 28672
    s_nop 0
    buffer_load_dwordx4 v19, s[8:11], s61 offen lds
    s_waitcnt lgkmcnt(3)
    v_mfma_f32_16x16x32_bf16 v[48:51], v[28:31], v[128:131], v[48:51]
    s_waitcnt lgkmcnt(2)
    v_mfma_f32_16x16x32_bf16 v[48:51], v[28:31], v[132:135], v[48:51]
    s_waitcnt lgkmcnt(1)
    v_mfma_f32_16x16x32_bf16 v[48:51], v[28:31], v[136:139], v[48:51]
    s_waitcnt lgkmcnt(0)
    v_mfma_f32_16x16x32_bf16 v[48:51], v[28:31], v[140:143], v[48:51]
    s_waitcnt vmcnt(4)
    ds_read_b128 v[144:147], v20 offset:0
    ds_read_b128 v[148:151], v21 offset:0
    ds_read_b128 v[152:155], v22 offset:0
    ds_read_b128 v[156:159], v23 offset:0
    v_mfma_f32_32x32x16_bf16 v[64:79], v[128:131], v[128:131], v[64:79]
    s_add_u32 m0, s26, 32768
    s_lshr_b32 s61, s21, 5
    buffer_load_dwordx4 v16, s[8:11], s61 offen lds
    v_mfma_f32_32x32x16_bf16 v[64:79], v[132:135], v[132:135], v[64:79]
    s_add_u32 m0, s26, 36864
    s_nop 0
    buffer_load_dwordx4 v17, s[8:11], s61 offen lds
    v_mfma_f32_32x32x16_bf16 v[64:79], v[136:139], v[136:139], v[64:79]
    s_add_u32 m0, s26, 40960
    s_nop 0
    buffer_load_dwordx4 v18, s[8:11], s61 offen lds
    v_mfma_f32_32x32x16_bf16 v[64:79], v[140:143], v[140:143], v[64:79]
    s_add_u32 m0, s26, 45056
    s_nop 0
    buffer_load_dwordx4 v19, s[8:11], s61 offen lds
    s_waitcnt lgkmcnt(3)
    v_mfma_f32_16x16x32_bf16 v[48:51], v[28:31], v[144:147], v[48:51]
    s_waitcnt lgkmcnt(2)
    v_mfma_f32_16x16x32_bf16 v[48:51], v[28:31], v[148:151], v[48:51]
    s_waitcnt lgkmcnt(1)
    v_mfma_f32_16x16x32_bf16 v[48:51], v[28:31], v[152:155], v[48:51]
    s_waitcnt lgkmcnt(0)
    v_mfma_f32_16x16x32_bf16 v[48:51], v[28:31], v[156:159], v[48:51]
    s_waitcnt vmcnt(4)
    ds_read_b128 v[160:163], v20 offset:16384
    ds_read_b128 v[164:167], v21 offset:16384
    ds_read_b128 v[168:171], v22 offset:16384
    ds_read_b128 v[172:175], v23 offset:16384
    s_cmp_lg_u32 s54, 1
    s_cbranch_scc1 L_nob
    v_lshlrev_b32 v34, 16, v32
    v_and_b32 v35, 0xffff0000, v32
    v_lshrrev_b32 v33, 1, v2
    v_add_u32 v33, 160768, v33
    ds_write_b64 v33, v[34:35]
    s_waitcnt lgkmcnt(0)
L_nob:
    v_mfma_f32_32x32x16_bf16 v[64:79], v[144:147], v[144:147], v[64:79]
    s_add_u32 m0, s26, 49152
    s_lshr_b32 s61, s22, 5
    buffer_load_dwordx4 v16, s[8:11], s61 offen lds
    v_mfma_f32_32x32x16_bf16 v[64:79], v[148:151], v[148:151], v[64:79]
    s_add_u32 m0, s26, 53248
    s_nop 0
    buffer_load_dwordx4 v17, s[8:11], s61 offen lds
    v_mfma_f32_32x32x16_bf16 v[64:79], v[152:155], v[152:155], v[64:79]
    s_add_u32 m0, s26, 57344
    s_nop 0
    buffer_load_dwordx4 v18, s[8:11], s61 offen lds
    v_mfma_f32_32x32x16_bf16 v[64:79], v[156:159], v[156:159], v[64:79]
    s_add_u32 m0, s26, 61440
    s_nop 0
    buffer_load_dwordx4 v19, s[8:11], s61 offen lds
    s_waitcnt lgkmcnt(3)
    v_mfma_f32_16x16x32_bf16 v[48:51], v[28:31], v[160:163], v[48:51]
    s_waitcnt lgkmcnt(2)
    v_mfma_f32_16x16x32_bf16 v[48:51], v[28:31], v[164:167], v[48:51]
    s_waitcnt lgkmcnt(1)
    v_mfma_f32_16x16x32_bf16 v[48:51], v[28:31], v[168:171], v[48:51]
    s_waitcnt lgkmcnt(0)
    v_mfma_f32_16x16x32_bf16 v[48:51], v[28:31], v[172:175], v[48:51]
    s_waitcnt vmcnt(4)
    ds_read_b128 v[176:179], v20 offset:32768
    ds_read_b128 v[180:183], v21 offset:32768
    ds_read_b128 v[184:187], v22 offset:32768
    ds_read_b128 v[188:191], v23 offset:32768
    v_mfma_f32_32x32x16_bf16 v[64:79], v[160:163], v[160:163], v[64:79]
    s_add_u32 m0, s26, 65536
    s_lshr_b32 s61, s23, 5
    buffer_load_dwordx4 v16, s[8:11], s61 offen lds
    v_mfma_f32_32x32x16_bf16 v[64:79], v[164:167], v[164:167], v[64:79]
    s_add_u32 m0, s26, 69632
    s_nop 0
    buffer_load_dwordx4 v17, s[8:11], s61 offen lds
    v_mfma_f32_32x32x16_bf16 v[64:79], v[168:171], v[168:171], v[64:79]
    s_add_u32 m0, s26, 73728
    s_nop 0
    buffer_load_dwordx4 v18, s[8:11], s61 offen lds
    v_mfma_f32_32x32x16_bf16 v[64:79], v[172:175], v[172:175], v[64:79]
    s_add_u32 m0, s26, 77824
    s_nop 0
    buffer_load_dwordx4 v19, s[8:11], s61 offen lds
    s_lshl_b32 s36, s53, 13
    s_waitcnt lgkmcnt(3)
    v_mfma_f32_16x16x32_bf16 v[48:51], v[28:31], v[176:179], v[48:51]
    s_waitcnt lgkmcnt(2)
    v_mfma_f32_16x16x32_bf16 v[48:51], v[28:31], v[180:183], v[48:51]
    s_waitcnt lgkmcnt(1)
    v_mfma_f32_16x16x32_bf16 v[48:51], v[28:31], v[184:187], v[48:51]
    s_waitcnt lgkmcnt(0)
    v_mfma_f32_16x16x32_bf16 v[48:51], v[28:31], v[188:191], v[48:51]
    s_lshl_b32 s61, s54, 11
    s_add_u32 s36, s36, s61
    s_add_u32 s36, s36, 131072
    v_min_u32 v0, 144, v2
    v_lshlrev_b32 v0, 3, v0
    buffer_load_dwordx2 v[0:1], v0, s[4:7], s36 offen offset:0 sc1
    ds_read_b64_tr_b16 a[96:97], v46 offset:4096
    ds_read_b64_tr_b16 a[98:99], v46 offset:5120
    ds_read_b64_tr_b16 a[100:101], v46 offset:4160
    ds_read_b64_tr_b16 a[102:103], v46 offset:5184
    ds_read_b64_tr_b16 a[104:105], v46 offset:4224
    ds_read_b64_tr_b16 a[106:107], v46 offset:5248
    s_waitcnt vmcnt(5)
    ds_read_b128 v[192:195], v20 offset:49152
    ds_read_b128 v[196:199], v21 offset:49152
    ds_read_b128 v[200:203], v22 offset:49152
    ds_read_b128 v[204:207], v23 offset:49152
    v_mfma_f32_32x32x16_bf16 v[64:79], v[176:179], v[176:179], v[64:79]
    s_add_u32 m0, s26, 81920
    s_lshr_b32 s61, s24, 5
    buffer_load_dwordx4 v16, s[8:11], s61 offen lds
    v_mfma_f32_32x32x16_bf16 v[64:79], v[180:183], v[180:183], v[64:79]
    s_add_u32 m0, s26, 86016
    s_nop 0
    buffer_load_dwordx4 v17, s[8:11], s61 offen lds
    v_mfma_f32_32x32x16_bf16 v[64:79], v[184:187], v[184:187], v[64:79]
    s_add_u32 m0, s26, 90112
    s_nop 0
    buffer_load_dwordx4 v18, s[8:11], s61 offen lds
    v_mfma_f32_32x32x16_bf16 v[64:79], v[188:191], v[188:191], v[64:79]
    s_add_u32 m0, s26, 94208
    s_nop 0
    buffer_load_dwordx4 v19, s[8:11], s61 offen lds
    s_waitcnt lgkmcnt(3)
    v_mfma_f32_16x16x32_bf16 v[48:51], v[28:31], v[192:195], v[48:51]
    s_waitcnt lgkmcnt(2)
    v_mfma_f32_16x16x32_bf16 v[48:51], v[28:31], v[196:199], v[48:51]
    s_waitcnt lgkmcnt(1)
    v_mfma_f32_16x16x32_bf16 v[48:51], v[28:31], v[200:203], v[48:51]
    s_waitcnt lgkmcnt(0)
    v_mfma_f32_16x16x32_bf16 v[48:51], v[28:31], v[204:207], v[48:51]
    s_waitcnt vmcnt(5)
    ds_read_b128 v[208:211], v24 offset:0
    ds_read_b128 v[212:215], v25 offset:0
    ds_read_b128 v[216:219], v26 offset:0
    ds_read_b128 v[220:223], v27 offset:0
    v_mfma_f32_32x32x16_bf16 v[64:79], v[192:195], v[192:195], v[64:79]
    s_add_u32 m0, s26, 98304
    s_lshr_b32 s61, s25, 5
    buffer_load_dwordx4 v16, s[8:11], s61 offen lds
    v_mfma_f32_32x32x16_bf16 v[64:79], v[196:199], v[196:199], v[64:79]
    s_add_u32 m0, s26, 102400
    s_nop 0
    buffer_load_dwordx4 v17, s[8:11], s61 offen lds
    v_mfma_f32_32x32x16_bf16 v[64:79], v[200:203], v[200:203], v[64:79]
    s_add_u32 m0, s26, 106496
    s_nop 0
    buffer_load_dwordx4 v18, s[8:11], s61 offen lds
    v_mfma_f32_32x32x16_bf16 v[64:79], v[204:207], v[204:207], v[64:79]
    s_add_u32 m0, s26, 110592
    s_nop 0
    buffer_load_dwordx4 v19, s[8:11], s61 offen lds
    s_waitcnt lgkmcnt(3)
    v_mfma_f32_16x16x32_bf16 v[48:51], v[28:31], v[208:211], v[48:51]
    s_waitcnt lgkmcnt(2)
    v_mfma_f32_16x16x32_bf16 v[48:51], v[28:31], v[212:215], v[48:51]
    s_waitcnt lgkmcnt(1)
    v_mfma_f32_16x16x32_bf16 v[48:51], v[28:31], v[216:219], v[48:51]
    s_waitcnt lgkmcnt(0)
    v_mfma_f32_16x16x32_bf16 v[48:51], v[28:31], v[220:223], v[48:51]
    s_mov_b32 m0, s70
    s_mov_b32 s61, s79
    buffer_load_dwordx4 v60, s[8:11], s61 offen offset:0 lds
    s_add_u32 s61, s61, 4080
    buffer_load_dwordx4 v60, s[8:11], s61 offen offset:1040 lds
    s_add_u32 s61, s61, 4080
    buffer_load_dwordx4 v60, s[8:11], s61 offen offset:2080 lds
    s_add_u32 s61, s61, 4080
    buffer_load_dwordx4 v60, s[8:11], s61 offen offset:3120 lds
    s_waitcnt vmcnt(12)
    v_cmp_ne_u64 vcc, s[58:59], v[0:1]
    s_nop 0
    s_cbranch_vccnz L_p1_retry
L_p1_ok:
    s_barrier
    s_add_u32 m0, s26, 0
    s_nop 0
    buffer_load_dwordx4 v3, s[4:7], s16 offen sc1 lds
    s_add_u32 m0, s26, 4096
    s_nop 0
    buffer_load_dwordx4 v3, s[4:7], s17 offen sc1 lds
    s_add_u32 m0, s26, 8192
    s_nop 0
    buffer_load_dwordx4 v3, s[4:7], s18 offen sc1 lds
    s_add_u32 m0, s26, 12288
    s_nop 0
    buffer_load_dwordx4 v3, s[4:7], s19 offen sc1 lds
    s_add_u32 m0, s26, 16384
    s_nop 0
    buffer_load_dwordx4 v3, s[4:7], s20 offen sc1 lds
    s_add_u32 m0, s26, 20480
    s_nop 0
    buffer_load_dwordx4 v3, s[4:7], s21 offen sc1 lds
    s_waitcnt vmcnt(14)
    ds_read_b128 v[224:227], v24 offset:16384
    ds_read_b128 v[228:231], v25 offset:16384
    ds_read_b128 v[232:235], v26 offset:16384
    ds_read_b128 v[236:239], v27 offset:16384
    v_mfma_f32_32x32x16_bf16 v[64:79], v[208:211], v[208:211], v[64:79]
    v_mfma_f32_32x32x16_bf16 v[64:79], v[212:215], v[212:215], v[64:79]
    v_mfma_f32_32x32x16_bf16 v[64:79], v[216:219], v[216:219], v[64:79]
    v_mfma_f32_32x32x16_bf16 v[64:79], v[220:223], v[220:223], v[64:79]
    s_waitcnt lgkmcnt(3)
    v_mfma_f32_16x16x32_bf16 v[48:51], v[28:31], v[224:227], v[48:51]
    s_waitcnt lgkmcnt(2)
    v_mfma_f32_16x16x32_bf16 v[48:51], v[28:31], v[228:231], v[48:51]
    s_waitcnt lgkmcnt(1)
    v_mfma_f32_16x16x32_bf16 v[48:51], v[28:31], v[232:235], v[48:51]
    s_waitcnt lgkmcnt(0)
    v_mfma_f32_16x16x32_bf16 v[48:51], v[28:31], v[236:239], v[48:51]
    s_waitcnt vmcnt(10)
    ds_read_b128 v[240:243], v24 offset:32768
    ds_read_b128 v[244:247], v25 offset:32768
    ds_read_b128 v[248:251], v26 offset:32768
    ds_read_b128 v[252:255], v27 offset:32768
    v_mfma_f32_32x32x16_bf16 v[64:79], v[224:227], v[224:227], v[64:79]
    v_mfma_f32_32x32x16_bf16 v[64:79], v[228:231], v[228:231], v[64:79]
    v_mfma_f32_32x32x16_bf16 v[64:79], v[232:235], v[232:235], v[64:79]
    v_mfma_f32_32x32x16_bf16 v[64:79], v[236:239], v[236:239], v[64:79]
    s_waitcnt lgkmcnt(3)
    v_mfma_f32_16x16x32_bf16 v[48:51], v[28:31], v[240:243], v[48:51]
    s_waitcnt lgkmcnt(2)
    v_mfma_f32_16x16x32_bf16 v[48:51], v[28:31], v[244:247], v[48:51]
    s_waitcnt lgkmcnt(1)
    v_mfma_f32_16x16x32_bf16 v[48:51], v[28:31], v[248:251], v[48:51]
    s_waitcnt lgkmcnt(0)
    v_mfma_f32_16x16x32_bf16 v[48:51], v[28:31], v[252:255], v[48:51]
    s_branch L_join
L_roleW:
    v_mov_b32 v12, 0
    v_mov_b32 v13, 0
    v_mov_b32 v14, 0
    v_mov_b32 v15, 0
    s_mov_b32 s8, s16
    s_mov_b32 s9, s17
    s_mov_b32 s10, 2621440
    s_mov_b32 s11, 0x20000
    s_mov_b32 s36, s22
    s_mov_b32 s37, s23
    s_mov_b32 s72, s30
    s_mov_b32 s73, s31
    s_mov_b32 s16, s69
    s_lshl_b32 s26, s54, 10
    s_add_u32 m0, s26, 65536
    s_lshr_b32 s61, s16, 5
    buffer_load_dwordx4 v16, s[8:11], s61 offen lds
    s_add_u32 m0, s26, 69632
    s_nop 0
    buffer_load_dwordx4 v17, s[8:11], s61 offen lds
    s_add_u32 m0, s26, 73728
    s_nop 0
    buffer_load_dwordx4 v18, s[8:11], s61 offen lds
    s_add_u32 m0, s26, 77824
    s_nop 0
    buffer_load_dwordx4 v19, s[8:11], s61 offen lds
    s_mov_b32 s4, s38
    s_mov_b32 s5, s39
    s_mov_b32 s6, 268435456
    s_mov_b32 s7, 0x20000
    s_load_dwordx2 s[58:59], s[38:39], 0
    s_add_u32 s17, s16, 4096
    s_cmp_eq_u32 s17, 40960
    s_cselect_b32 s17, 0, s17
    s_add_u32 s18, s17, 4096
    s_cmp_eq_u32 s18, 40960
    s_cselect_b32 s18, 0, s18
    s_add_u32 s19, s18, 4096
    s_cmp_eq_u32 s19, 40960
    s_cselect_b32 s19, 0, s19
    v_lshrrev_b32 v11, 5, v1
    v_lshrrev_b32 v36, 2, v9
    v_and_b32 v37, 3, v9
    s_mul_i32 s27, s53, 286720
    s_add_u32 s27, s27, 524288
    v_mov_b32 v59, v7
    s_mov_b32 s40, s34
    s_mov_b32 s41, s35
    s_mov_b32 s42, 2621440
    s_mov_b32 s43, 0x20000
    s_add_u32 s20, s19, 4096
    s_cmp_eq_u32 s20, 40960
    s_cselect_b32 s20, 0, s20
    s_add_u32 s21, s20, 4096
    s_cmp_eq_u32 s21, 40960
    s_cselect_b32 s21, 0, s21
    s_add_u32 s22, s21, 4096
    s_cmp_eq_u32 s22, 40960
    s_cselect_b32 s22, 0, s22
    s_add_u32 s23, s22, 4096
    s_cmp_eq_u32 s23, 40960
    s_cselect_b32 s23, 0, s23
    s_add_u32 s24, s23, 4096
    s_cmp_eq_u32 s24, 40960
    s_cselect_b32 s24, 0, s24
    s_add_u32 s25, s24, 4096
    s_cmp_eq_u32 s25, 40960
    s_cselect_b32 s25, 0, s25
    s_mov_b32 s44, s32
    s_mov_b32 s45, s33
    s_mov_b32 s46, 1280
    s_mov_b32 s47, 0x20000
    s_and_b32 s56, s53, 7
    s_lshr_b32 s65, s53, 3
    s_lshl_b32 s66, s52, 1
    s_add_u32 s55, s66, s65
    s_mov_b32 s57, 400000
    s_mul_i32 s80, s56, 160
    v_lshl_add_u32 v6, v1, 2, s80
    s_mov_b32 m0, 161280
    s_nop 0
    buffer_load_dword v6, s[44:47], 0 offen lds
    s_lshl_b32 s79, s55, 6
    s_lshl_b32 s66, s54, 4
    s_add_u32 s79, s79, s66
    s_mul_i32 s79, s79, 1280
    s_add_u32 s79, s79, s80
    v_lshlrev_b32 v61, 1, v8
    v_sub_u32 v61, v9, v61
    v_cmp_gt_u32 vcc, 10, v61
    v_mul_u32_u24 v60, 1280, v8
    v_lshl_add_u32 v60, v61, 4, v60
    v_cndmask_b32 v60, v7, v60, vcc
    v_and_b32 v10, 31, v1
    v_bfe_u32 v6, v10, 1, 3
    v_xor_b32 v6, v6, v11
    v_lshlrev_b32 v6, 4, v6
    v_and_b32 v20, 7, v10
    v_lshl_add_u32 v6, v20, 7, v6
    v_lshrrev_b32 v20, 3, v10
    v_lshl_add_u32 v6, v20, 12, v6
    v_add_u32 v20, s26, v6
    v_xor_b32 v21, 32, v20
    v_xor_b32 v22, 64, v20
    v_xor_b32 v23, 0x60, v20
    v_add_u32 v24, 0x10000, v20
    v_add_u32 v25, 0x10000, v21
    v_add_u32 v26, 0x10000, v22
    v_add_u32 v27, 0x10000, v23
    v_lshrrev_b32 v6, 2, v9
    v_xor_b32 v6, v6, v8
    v_and_b32 v6, 1, v6
    v_cmp_eq_u32 vcc, 0, v6
    v_mov_b32 v6, 0x3f803f80
    s_nop 0
    v_cndmask_b32 v28, 0, v6, vcc
    v_mov_b32 v29, v28
    v_mov_b32 v30, v28
    v_mov_b32 v31, v28
    s_waitcnt lgkmcnt(0)
    s_mul_i32 s58, s58, 1664525
    s_add_u32 s58, s58, 1013904223
    s_mul_i32 s59, s59, 22695477
    s_add_u32 s59, s59, 1
    v_mov_b32 v40, s58
    v_mov_b32 v41, s59
    v_accvgpr_write_b32 a252, v40
    v_accvgpr_write_b32 a253, v41
    s_add_u32 m0, s26, 81920
    s_lshr_b32 s61, s17, 5
    buffer_load_dwordx4 v16, s[8:11], s61 offen lds
    s_add_u32 m0, s26, 86016
    s_nop 0
    buffer_load_dwordx4 v17, s[8:11], s61 offen lds
    s_add_u32 m0, s26, 90112
    s_nop 0
    buffer_load_dwordx4 v18, s[8:11], s61 offen lds
    s_add_u32 m0, s26, 94208
    s_nop 0
    buffer_load_dwordx4 v19, s[8:11], s61 offen lds
    s_add_u32 m0, s26, 98304
    s_lshr_b32 s61, s18, 5
    buffer_load_dwordx4 v16, s[8:11], s61 offen lds
    s_add_u32 m0, s26, 102400
    s_nop 0
    buffer_load_dwordx4 v17, s[8:11], s61 offen lds
    s_add_u32 m0, s26, 106496
    s_nop 0
    buffer_load_dwordx4 v18, s[8:11], s61 offen lds
    s_add_u32 m0, s26, 110592
    s_nop 0
    buffer_load_dwordx4 v19, s[8:11], s61 offen lds
    s_add_u32 s61, s27, s26
    v_add_u32 v3, s61, v2
    v_and_b32 v6, 1, v8
    v_lshlrev_b32 v6, 10, v6
    v_lshl_add_u32 v6, v11, 9, v6
    v_lshl_add_u32 v6, v9, 4, v6
    v_lshrrev_b32 v42, 2, v10
    v_mul_u32_u24 v42, 16, v42
    s_mul_i32 s61, s54, 5248
    s_add_u32 s61, s61, 65536
    s_mul_i32 s62, s54, 3200
    s_add_u32 s62, s62, 88064
    v_mul_u32_u24 v40, 160, v10
    v_mul_u32_u24 v41, 80, v11
    v_add3_u32 v40, v40, v41, s61
    v_add_u32 v40, v40, v42
    v_accvgpr_write_b32 a80, v40
    v_mul_u32_u24 v40, 96, v10
    v_mul_u32_u24 v41, 48, v11
    v_add3_u32 v40, v40, v41, s62
    v_add_u32 v40, v40, v42
    v_accvgpr_write_b32 a81, v40
    s_lshr_b32 s61, s54, 1
    s_mul_i32 s62, s61, 48
    s_mul_i32 s61, s61, 80
    s_add_u32 s61, s61, 65536
    s_and_b32 s63, s54, 1
    s_lshl_b32 s64, s63, 5
    s_add_u32 s62, s62, s64
    s_add_u32 s62, s62, 88064
    v_lshl_add_u32 v42, v8, 2, v36
    v_mul_u32_u24 v40, 160, v42
    v_mad_u32_u24 v40, v8, 16, v40
    v_add_u32 v40, s61, v40
    v_lshl_add_u32 v41, v37, 3, v40
    v_accvgpr_write_b32 a83, v41
    v_mul_u32_u24 v40, 96, v42
    v_mad_u32_u24 v40, v8, 16, v40
    v_add_u32 v40, s62, v40
    v_lshl_add_u32 v41, v37, 3, v40
    v_accvgpr_write_b32 a84, v41
    v_and_b32 v40, 1, v8
    v_lshrrev_b32 v41, 1, v37
    v_lshl_add_u32 v40, v40, 1, v41
    v_lshlrev_b32 v40, 3, v40
    v_mad_u32_u24 v40, v36, 40, v40
    v_mul_u32_u24 v41, 800, v11
    v_add_u32 v40, v40, v41
    v_add_u32 v40, 155648, v40
    v_and_b32 v41, 1, v37
    v_cmp_eq_u32 vcc, v41, v11
    v_mov_b32 v41, 157696
    s_nop 0
    v_cndmask_b32 v40, v41, v40, vcc
    v_accvgpr_write_b32 a85, v40
    s_lshl_b32 s61, s54, 14
    s_lshl_b32 s64, s63, 8
    s_add_u32 s61, s61, s64
    s_lshr_b32 s64, 16, s63
    s_lshr_b32 s65, 0x100, s63
    v_lshlrev_b32 v42, 4, v9
    v_mad_u32_u24 v40, v8, s65, v42
    v_add_u32 v40, s61, v40
    v_cmp_gt_u32 vcc, s64, v9
    s_nop 1
    v_cndmask_b32 v40, v7, v40, vcc
    v_accvgpr_write_b32 a86, v40
    s_or_b32 s61, s54, 1
    s_lshl_b32 s61, s61, 14
    s_mul_i32 s65, s63, 768
    s_add_u32 s61, s61, s65
    v_lshl_add_u32 v40, v8, 3, v42
    v_add_u32 v40, s61, v40
    s_mov_b32 vcc_hi, 0
    s_nop 1
    v_cndmask_b32 v7, v7, v40, vcc
    s_lshl_b32 s31, s53, 16
    s_lshl_b32 s61, s52, 10
    s_add_u32 s31, s31, s61
    s_add_u32 s31, s31, 16842752
    v_subrev_u32 v40, 16, v1
    v_lshrrev_b32 v41, 3, v40
    v_min_u32 v41, 4, v41
    v_and_b32 v40, 7, v40
    v_min_u32 v40, 4, v40
    v_add_u32 v40, 16, v40
    v_cmp_gt_u32 vcc, 16, v1
    v_lshlrev_b32 v42, 3, v41
    s_nop 0
    v_cndmask_b32 v40, v40, v1, vcc
    v_cndmask_b32 v42, v42, 0, vcc
    v_add_u32 v42, v42, v40
    s_cmp_eq_u32 s63, 0
    s_cselect_b64 vcc, -1, 0
    v_cndmask_b32 v40, v40, v9, vcc
    v_cndmask_b32 v41, v41, v8, vcc
    v_cndmask_b32 v42, v42, v1, vcc
    s_lshr_b32 s61, s54, 1
    s_mul_i32 s61, s61, 2560
    s_add_u32 s61, s61, 102400
    v_lshlrev_b32 v40, 4, v40
    v_lshl_add_u32 v40, v41, 9, v40
    v_lshl_add_u32 v40, v42, 24, v40
    v_add_u32 v40, s61, v40
    v_accvgpr_write_b32 a254, v40
    v_bfe_u32 v40, v2, 7, 2
    v_and_b32 v41, 0x30, v2
    v_lshl_add_u32 v40, v40, 6, v41
    v_mul_u32_u24 v41, 2560, v11
    v_add_u32 v40, v40, v41
    v_add_u32 v40, 102400, v40
    v_bfe_u32 v41, v2, 6, 1
    v_cmp_eq_u32 vcc, v41, v11
    v_mov_b32 v41, 157696
    s_nop 0
    v_cndmask_b32 v40, v41, v40, vcc
    v_accvgpr_write_b32 a255, v40
    s_lshl_b32 s61, s52, 1
    s_lshr_b32 s62, s54, 1
    s_add_u32 s61, s61, s62
    s_mul_i32 s30, s61, 278528
    s_lshl_b32 s62, s63, 11
    s_add_u32 s30, s30, s62
    s_add_u32 s38, s30, 8192000
    s_lshr_b32 s62, s53, 2
    s_lshl_b32 s64, s62, 12
    s_add_u32 s38, s38, s64
    s_and_b32 s64, s53, 3
    s_lshl_b32 s65, s64, 8
    s_add_u32 s38, s38, s65
    s_lshl_b32 s65, s53, 12
    s_add_u32 s30, s30, s65
    s_add_u32 s30, s30, 7929856
    s_lshl_b32 s32, s52, 15
    s_lshl_b32 s62, s62, 13
    s_add_u32 s32, s32, s62
    s_lshl_b32 s64, s64, 9
    s_add_u32 s32, s32, s64
    s_lshl_b32 s63, s54, 7
    s_add_u32 s32, s32, s63
    s_add_u32 s32, s32, 18022400
    s_lshl_b32 s39, s53, 13
    s_add_u32 s39, s39, 17891328
    s_lshl_b32 s62, s60, 7
    s_add_u32 s33, s39, s62
    s_lshr_b32 s62, s54, 1
    s_lshl_b32 s62, s62, 12
    s_add_u32 s39, s39, s62
    v_bfe_u32 v40, v10, 3, 1
    v_bfe_u32 v41, v10, 1, 1
    v_lshl_add_u32 v40, v40, 1, v41
    v_lshrrev_b32 v41, 4, v10
    v_lshl_add_u32 v40, v41, 2, v40
    v_and_b32 v41, 1, v10
    v_lshlrev_b32 v41, 4, v41
    v_mov_b32 v42, 0x3f80
    v_lshlrev_b32 v41, v41, v42
    v_bfe_u32 v42, v10, 2, 1
    v_cmp_eq_u32 vcc, v42, v11
    s_nop 1
    v_cndmask_b32 v41, 0, v41, vcc
    v_cmp_eq_u32 vcc, 0, v40
    s_nop 1
    v_cndmask_b32 v42, 0, v41, vcc
    v_accvgpr_write_b32 a88, v42
    v_cmp_eq_u32 vcc, 1, v40
    s_nop 1
    v_cndmask_b32 v42, 0, v41, vcc
    v_accvgpr_write_b32 a89, v42
    v_cmp_eq_u32 vcc, 2, v40
    s_nop 1
    v_cndmask_b32 v42, 0, v41, vcc
    v_accvgpr_write_b32 a90, v42
    v_cmp_eq_u32 vcc, 3, v40
    s_nop 1
    v_cndmask_b32 v42, 0, v41, vcc
    v_accvgpr_write_b32 a91, v42
    v_cmp_eq_u32 vcc, 4, v40
    s_nop 1
    v_cndmask_b32 v42, 0, v41, vcc
    v_accvgpr_write_b32 a60, v42
    v_cmp_eq_u32 vcc, 5, v40
    s_nop 1
    v_cndmask_b32 v42, 0, v41, vcc
    v_accvgpr_write_b32 a61, v42
    v_cmp_eq_u32 vcc, 6, v40
    s_nop 1
    v_cndmask_b32 v42, 0, v41, vcc
    v_accvgpr_write_b32 a62, v42
    v_cmp_eq_u32 vcc, 7, v40
    s_nop 1
    v_cndmask_b32 v42, 0, v41, vcc
    v_accvgpr_write_b32 a63, v42
    s_sub_u32 s71, s60, 48
    s_max_i32 s71, s71, 0
    s_min_i32 s71, s71, 10
    s_add_u32 s71, s71, s60
    s_sub_u32 s71, s71, 40
    s_and_b32 s61, s53, 1
    s_mul_i32 s61, s61, 34
    s_add_u32 s71, s61, s71
    s_mov_b32 s61, s71
    s_lshr_b32 s62, s53, 1
    s_and_b32 s63, s61, 15
    s_lshr_b32 s64, s61, 4
    s_mul_i32 s65, s63, 96
    s_lshl_b32 s66, s64, 5
    s_add_u32 s65, s65, s66
    s_mul_i32 s66, s63, 40
    s_mul_i32 s67, s63, 160
    s_add_u32 s67, s67, 16
    s_cmp_eq_u32 s64, 4
    s_cselect_b32 s66, s67, s66
    s_cselect_b32 s67, 80, 20
    s_cselect_b32 s68, 40, 8
    s_cselect_b32 s69, 20, 4
    s_cmp_lt_u32 s64, 3
    s_cselect_b32 s65, s65, s66
    s_cselect_b32 s67, 16, s67
    s_cselect_b32 s12, s72, s36
    s_cselect_b32 s13, s73, s37
    s_mov_b32 s14, 819200
    s_cselect_b32 s14, 1966080, s14
    s_mov_b32 s15, 0x20000
    s_mul_i32 s65, s65, 1280
    s_mul_i32 s62, s62, 160
    s_add_u32 s65, s65, s62
    s_mul_i32 s69, s69, 1280
    s_add_u32 s69, s69, s65
    v_lshrrev_b32 v10, 1, v8
    v_and_b32 v11, 1, v8
    v_mul_u32_u24 v10, s67, v10
    v_mad_u32_u24 v10, s68, v11, v10
    v_mul_u32_u24 v10, 1280, v10
    v_lshl_add_u32 v10, v9, 4, v10
    v_cmp_gt_u32 vcc, 10, v9
    s_nop 1
    v_cndmask_b32 v10, v59, v10, vcc
    s_add_u32 m0, s70, 0
    s_nop 0
    buffer_load_dwordx4 v10, s[12:15], s65 offen offset:0 lds
    s_add_u32 s65, s65, 256
    buffer_load_dwordx4 v10, s[12:15], s65 offen offset:1024 lds
    s_add_u32 s65, s65, 256
    buffer_load_dwordx4 v10, s[12:15], s65 offen offset:2048 lds
    s_add_u32 s65, s65, 256
    buffer_load_dwordx4 v10, s[12:15], s65 offen offset:3072 lds
    s_add_u32 m0, s70, 4096
    s_nop 0
    buffer_load_dwordx4 v10, s[12:15], s69 offen offset:0 lds
    s_add_u32 s69, s69, 256
    buffer_load_dwordx4 v10, s[12:15], s69 offen offset:1024 lds
    s_add_u32 s69, s69, 256
    buffer_load_dwordx4 v10, s[12:15], s69 offen offset:2048 lds
    s_add_u32 s69, s69, 256
    buffer_load_dwordx4 v10, s[12:15], s69 offen offset:3072 lds
    s_sub_u32 s61, s60, 48
    s_cmp_ge_u32 s61, 10
    s_cbranch_scc1 L_w1
    s_add_u32 s61, s71, 1
    s_lshr_b32 s62, s53, 1
    s_and_b32 s63, s61, 15
    s_lshr_b32 s64, s61, 4
    s_mul_i32 s65, s63, 96
    s_lshl_b32 s66, s64, 5
    s_add_u32 s65, s65, s66
    s_mul_i32 s66, s63, 40
    s_mul_i32 s67, s63, 160
    s_add_u32 s67, s67, 16
    s_cmp_eq_u32 s64, 4
    s_cselect_b32 s66, s67, s66
    s_cselect_b32 s67, 80, 20
    s_cselect_b32 s68, 40, 8
    s_cselect_b32 s69, 20, 4
    s_cmp_lt_u32 s64, 3
    s_cselect_b32 s65, s65, s66
    s_cselect_b32 s67, 16, s67
    s_cselect_b32 s12, s72, s36
    s_cselect_b32 s13, s73, s37
    s_mov_b32 s14, 819200
    s_cselect_b32 s14, 1966080, s14
    s_mov_b32 s15, 0x20000
    s_mul_i32 s65, s65, 1280
    s_mul_i32 s62, s62, 160
    s_add_u32 s65, s65, s62
    s_mul_i32 s69, s69, 1280
    s_add_u32 s69, s69, s65
    v_lshrrev_b32 v10, 1, v8
    v_and_b32 v11, 1, v8
    v_mul_u32_u24 v10, s67, v10
    v_mad_u32_u24 v10, s68, v11, v10
    v_mul_u32_u24 v10, 1280, v10
    v_lshl_add_u32 v10, v9, 4, v10
    v_cmp_gt_u32 vcc, 10, v9
    s_nop 1
    v_cndmask_b32 v10, v59, v10, vcc
    s_add_u32 m0, s70, 8192
    s_nop 0
    buffer_load_dwordx4 v10, s[12:15], s65 offen offset:0 lds
    s_add_u32 s65, s65, 256
    buffer_load_dwordx4 v10, s[12:15], s65 offen offset:1024 lds
    s_add_u32 s65, s65, 256
    buffer_load_dwordx4 v10, s[12:15], s65 offen offset:2048 lds
    s_add_u32 s65, s65, 256
    buffer_load_dwordx4 v10, s[12:15], s65 offen offset:3072 lds
    s_add_u32 m0, s70, 12288
    s_nop 0
    buffer_load_dwordx4 v10, s[12:15], s69 offen offset:0 lds
    s_add_u32 s69, s69, 256
    buffer_load_dwordx4 v10, s[12:15], s69 offen offset:1024 lds
    s_add_u32 s69, s69, 256
    buffer_load_dwordx4 v10, s[12:15], s69 offen offset:2048 lds
    s_add_u32 s69, s69, 256
    buffer_load_dwordx4 v10, s[12:15], s69 offen offset:3072 lds
L_w1:
    v_and_b32 v10, 31, v1
    v_lshrrev_b32 v11, 5, v1
    v_lshlrev_b32 v46, 8, v8
    v_lshl_add_u32 v46, v36, 10, v46
    v_mad_u32_u24 v46, v37, 40, v46
    v_add_u32 v46, s70, v46
    s_lshr_b32 s62, s53, 1
    s_mul_i32 s28, s62, 348160
    s_mul_i32 s63, s71, 5120
    s_add_u32 s28, s28, s63
    s_add_u32 s28, s28, 5111808
    s_lshl_b32 s34, s62, 7
    s_add_u32 s34, s34, s71
    s_lshl_b32 s34, s34, 7
    s_add_u32 s34, s34, 393216
    s_sub_u32 s61, s60, 48
    s_cmp_lt_u32 s61, 10
    s_cselect_b64 vcc, -1, 0
    s_cselect_b32 s69, 16, 8
    s_mov_b32 s29, 1024
    v_mov_b32 v62, v2
    v_cndmask_b32 v63, v59, v2, vcc
    s_waitcnt vmcnt(17)
    ds_read_b128 v[96:99], v24 offset:0
    ds_read_b128 v[100:103], v25 offset:0
    ds_read_b128 v[104:107], v26 offset:0
    ds_read_b128 v[108:111], v27 offset:0
    s_waitcnt lgkmcnt(3)
    v_mfma_f32_16x16x32_bf16 v[48:51], v[28:31], v[96:99], 0
    s_waitcnt lgkmcnt(2)
    v_mfma_f32_16x16x32_bf16 v[48:51], v[28:31], v[100:103], v[48:51]
    s_waitcnt lgkmcnt(1)
    v_mfma_f32_16x16x32_bf16 v[48:51], v[28:31], v[104:107], v[48:51]
    s_waitcnt lgkmcnt(0)
    v_mfma_f32_16x16x32_bf16 v[48:51], v[28:31], v[108:111], v[48:51]
    s_waitcnt vmcnt(12)
    ds_read_b128 v[112:115], v24 offset:16384
    ds_read_b128 v[116:119], v25 offset:16384
    ds_read_b128 v[120:123], v26 offset:16384
    ds_read_b128 v[124:127], v27 offset:16384
    v_mfma_f32_32x32x16_bf16 v[64:79], v[96:99], v[96:99], 0
    s_add_u32 m0, s26, 0
    s_lshr_b32 s61, s19, 5
    buffer_load_dwordx4 v16, s[8:11], s61 offen lds
    v_mfma_f32_32x32x16_bf16 v[64:79], v[100:103], v[100:103], v[64:79]
    s_add_u32 m0, s26, 4096
    s_nop 0
    buffer_load_dwordx4 v17, s[8:11], s61 offen lds
    v_mfma_f32_32x32x16_bf16 v[64:79], v[104:107], v[104:107], v[64:79]
    s_add_u32 m0, s26, 8192
    s_nop 0
    buffer_load_dwordx4 v18, s[8:11], s61 offen lds
    v_mfma_f32_32x32x16_bf16 v[64:79], v[108:111], v[108:111], v[64:79]
    s_add_u32 m0, s26, 12288
    s_nop 0
    buffer_load_dwordx4 v19, s[8:11], s61 offen lds
    s_waitcnt lgkmcnt(3)
    v_mfma_f32_16x16x32_bf16 v[48:51], v[28:31], v[112:115], v[48:51]
    s_waitcnt lgkmcnt(2)
    v_mfma_f32_16x16x32_bf16 v[48:51], v[28:31], v[116:119], v[48:51]
    s_waitcnt lgkmcnt(1)
    v_mfma_f32_16x16x32_bf16 v[48:51], v[28:31], v[120:123], v[48:51]
    s_waitcnt lgkmcnt(0)
    v_mfma_f32_16x16x32_bf16 v[48:51], v[28:31], v[124:127], v[48:51]
    s_waitcnt vmcnt(12)
    ds_read_b128 v[128:131], v24 offset:32768
    ds_read_b128 v[132:135], v25 offset:32768
    ds_read_b128 v[136:139], v26 offset:32768
    ds_read_b128 v[140:143], v27 offset:32768
    v_mfma_f32_32x32x16_bf16 v[64:79], v[112:115], v[112:115], v[64:79]
    s_add_u32 m0, s26, 16384
    s_lshr_b32 s61, s20, 5
    buffer_load_dwordx4 v16, s[8:11], s61 offen lds
    v_mfma_f32_32x32x16_bf16 v[64:79], v[116:119], v[116:119], v[64:79]
    s_add_u32 m0, s26, 20480
    s_nop 0
    buffer_load_dwordx4 v17, s[8:11], s61 offen lds
    v_mfma_f32_32x32x16_bf16 v[64:79], v[120:123], v[120:123], v[64:79]
    s_add_u32 m0, s26, 24576
    s_nop 0
    buffer_load_dwordx4 v18, s[8:11], s61 offen lds
    v_mfma_f32_32x32x16_bf16 v[64:79], v[124:127], v[124:127], v[64:79]
    s_add_u32 m0, s26, 28672
    s_nop 0
    buffer_load_dwordx4 v19, s[8:11], s61 offen lds
    s_waitcnt lgkmcnt(3)
    v_mfma_f32_16x16x32_bf16 v[48:51], v[28:31], v[128:131], v[48:51]
    s_waitcnt lgkmcnt(2)
    v_mfma_f32_16x16x32_bf16 v[48:51], v[28:31], v[132:135], v[48:51]
    s_waitcnt lgkmcnt(1)
    v_mfma_f32_16x16x32_bf16 v[48:51], v[28:31], v[136:139], v[48:51]
    s_waitcnt lgkmcnt(0)
    v_mfma_f32_16x16x32_bf16 v[48:51], v[28:31], v[140:143], v[48:51]
    s_waitcnt vmcnt(4)
    ds_read_b128 v[144:147], v20 offset:0
    ds_read_b128 v[148:151], v21 offset:0
    ds_read_b128 v[152:155], v22 offset:0
    ds_read_b128 v[156:159], v23 offset:0
    v_mfma_f32_32x32x16_bf16 v[64:79], v[128:131], v[128:131], v[64:79]
    s_add_u32 m0, s26, 32768
    s_lshr_b32 s61, s21, 5
    buffer_load_dwordx4 v16, s[8:11], s61 offen lds
    v_mfma_f32_32x32x16_bf16 v[64:79], v[132:135], v[132:135], v[64:79]
    s_add_u32 m0, s26, 36864
    s_nop 0
    buffer_load_dwordx4 v17, s[8:11], s61 offen lds
    v_mfma_f32_32x32x16_bf16 v[64:79], v[136:139], v[136:139], v[64:79]
    s_add_u32 m0, s26, 40960
    s_nop 0
    buffer_load_dwordx4 v18, s[8:11], s61 offen lds
    v_mfma_f32_32x32x16_bf16 v[64:79], v[140:143], v[140:143], v[64:79]
    s_add_u32 m0, s26, 45056
    s_nop 0
    buffer_load_dwordx4 v19, s[8:11], s61 offen lds
    s_waitcnt lgkmcnt(3)
    v_mfma_f32_16x16x32_bf16 v[48:51], v[28:31], v[144:147], v[48:51]
    s_waitcnt lgkmcnt(2)
    v_mfma_f32_16x16x32_bf16 v[48:51], v[28:31], v[148:151], v[48:51]
    s_waitcnt lgkmcnt(1)
    v_mfma_f32_16x16x32_bf16 v[48:51], v[28:31], v[152:155], v[48:51]
    s_waitcnt lgkmcnt(0)
    v_mfma_f32_16x16x32_bf16 v[48:51], v[28:31], v[156:159], v[48:51]
    s_waitcnt vmcnt(4)
    ds_read_b128 v[160:163], v20 offset:16384
    ds_read_b128 v[164:167], v21 offset:16384
    ds_read_b128 v[168:171], v22 offset:16384
    ds_read_b128 v[172:175], v23 offset:16384
    v_mfma_f32_32x32x16_bf16 v[64:79], v[144:147], v[144:147], v[64:79]
    s_add_u32 m0, s26, 49152
    s_lshr_b32 s61, s22, 5
    buffer_load_dwordx4 v16, s[8:11], s61 offen lds
    v_mfma_f32_32x32x16_bf16 v[64:79], v[148:151], v[148:151], v[64:79]
    s_add_u32 m0, s26, 53248
    s_nop 0
    buffer_load_dwordx4 v17, s[8:11], s61 offen lds
    v_mfma_f32_32x32x16_bf16 v[64:79], v[152:155], v[152:155], v[64:79]
    s_add_u32 m0, s26, 57344
    s_nop 0
    buffer_load_dwordx4 v18, s[8:11], s61 offen lds
    v_mfma_f32_32x32x16_bf16 v[64:79], v[156:159], v[156:159], v[64:79]
    s_add_u32 m0, s26, 61440
    s_nop 0
    buffer_load_dwordx4 v19, s[8:11], s61 offen lds
    s_waitcnt lgkmcnt(3)
    v_mfma_f32_16x16x32_bf16 v[48:51], v[28:31], v[160:163], v[48:51]
    s_waitcnt lgkmcnt(2)
    v_mfma_f32_16x16x32_bf16 v[48:51], v[28:31], v[164:167], v[48:51]
    s_waitcnt lgkmcnt(1)
    v_mfma_f32_16x16x32_bf16 v[48:51], v[28:31], v[168:171], v[48:51]
    s_waitcnt lgkmcnt(0)
    v_mfma_f32_16x16x32_bf16 v[48:51], v[28:31], v[172:175], v[48:51]
    s_waitcnt vmcnt(4)
    ds_read_b128 v[176:179], v20 offset:32768
    ds_read_b128 v[180:183], v21 offset:32768
    ds_read_b128 v[184:187], v22 offset:32768
    ds_read_b128 v[188:191], v23 offset:32768
    v_mfma_f32_32x32x16_bf16 v[64:79], v[160:163], v[160:163], v[64:79]
    s_add_u32 m0, s26, 65536
    s_lshr_b32 s61, s23, 5
    buffer_load_dwordx4 v16, s[8:11], s61 offen lds
    v_mfma_f32_32x32x16_bf16 v[64:79], v[164:167], v[164:167], v[64:79]
    s_add_u32 m0, s26, 69632
    s_nop 0
    buffer_load_dwordx4 v17, s[8:11], s61 offen lds
    v_mfma_f32_32x32x16_bf16 v[64:79], v[168:171], v[168:171], v[64:79]
    s_add_u32 m0, s26, 73728
    s_nop 0
    buffer_load_dwordx4 v18, s[8:11], s61 offen lds
    v_mfma_f32_32x32x16_bf16 v[64:79], v[172:175], v[172:175], v[64:79]
    s_add_u32 m0, s26, 77824
    s_nop 0
    buffer_load_dwordx4 v19, s[8:11], s61 offen lds
    s_lshl_b32 s36, s53, 13
    s_waitcnt lgkmcnt(3)
    v_mfma_f32_16x16x32_bf16 v[48:51], v[28:31], v[176:179], v[48:51]
    s_waitcnt lgkmcnt(2)
    v_mfma_f32_16x16x32_bf16 v[48:51], v[28:31], v[180:183], v[48:51]
    s_waitcnt lgkmcnt(1)
    v_mfma_f32_16x16x32_bf16 v[48:51], v[28:31], v[184:187], v[48:51]
    s_waitcnt lgkmcnt(0)
    v_mfma_f32_16x16x32_bf16 v[48:51], v[28:31], v[188:191], v[48:51]
    s_lshl_b32 s61, s54, 11
    s_add_u32 s36, s36, s61
    s_add_u32 s36, s36, 131072
    v_min_u32 v0, 144, v2
    v_lshlrev_b32 v0, 3, v0
    buffer_load_dwordx2 v[0:1], v0, s[4:7], s36 offen offset:0 sc1
    ds_read_b64_tr_b16 a[92:93], v46 offset:0
    ds_read_b64_tr_b16 a[94:95], v46 offset:4096
    ds_read_b64_tr_b16 a[96:97], v46 offset:8
    ds_read_b64_tr_b16 a[98:99], v46 offset:4104
    ds_read_b64_tr_b16 a[100:101], v46 offset:16
    ds_read_b64_tr_b16 a[102:103], v46 offset:4112
    ds_read_b64_tr_b16 a[104:105], v46 offset:24
    ds_read_b64_tr_b16 a[106:107], v46 offset:4120
    ds_read_b64_tr_b16 a[108:109], v46 offset:32
    ds_read_b64_tr_b16 a[110:111], v46 offset:4128
    ds_read_b64_tr_b16 a[112:113], v46 offset:8192
    ds_read_b64_tr_b16 a[114:115], v46 offset:12288
    ds_read_b64_tr_b16 a[116:117], v46 offset:8200
    ds_read_b64_tr_b16 a[118:119], v46 offset:12296
    ds_read_b64_tr_b16 a[120:121], v46 offset:8208
    ds_read_b64_tr_b16 a[122:123], v46 offset:12304
    ds_read_b64_tr_b16 a[124:125], v46 offset:8216
    ds_read_b64_tr_b16 a[126:127], v46 offset:12312
    ds_read_b64_tr_b16 a[128:129], v46 offset:8224
    ds_read_b64_tr_b16 a[130:131], v46 offset:12320
    s_waitcnt vmcnt(5)
    ds_read_b128 v[192:195], v20 offset:49152
    ds_read_b128 v[196:199], v21 offset:49152
    ds_read_b128 v[200:203], v22 offset:49152
    ds_read_b128 v[204:207], v23 offset:49152
    v_mfma_f32_32x32x16_bf16 v[64:79], v[176:179], v[176:179], v[64:79]
    s_add_u32 m0, s26, 81920
    s_lshr_b32 s61, s24, 5
    buffer_load_dwordx4 v16, s[8:11], s61 offen lds
    v_mfma_f32_32x32x16_bf16 v[64:79], v[180:183], v[180:183], v[64:79]
    s_add_u32 m0, s26, 86016
    s_nop 0
    buffer_load_dwordx4 v17, s[8:11], s61 offen lds
    v_mfma_f32_32x32x16_bf16 v[64:79], v[184:187], v[184:187], v[64:79]
    s_add_u32 m0, s26, 90112
    s_nop 0
    buffer_load_dwordx4 v18, s[8:11], s61 offen lds
    v_mfma_f32_32x32x16_bf16 v[64:79], v[188:191], v[188:191], v[64:79]
    s_add_u32 m0, s26, 94208
    s_nop 0
    buffer_load_dwordx4 v19, s[8:11], s61 offen lds
    s_waitcnt lgkmcnt(3)
    v_mfma_f32_16x16x32_bf16 v[48:51], v[28:31], v[192:195], v[48:51]
    s_waitcnt lgkmcnt(2)
    v_mfma_f32_16x16x32_bf16 v[48:51], v[28:31], v[196:199], v[48:51]
    s_waitcnt lgkmcnt(1)
    v_mfma_f32_16x16x32_bf16 v[48:51], v[28:31], v[200:203], v[48:51]
    s_waitcnt lgkmcnt(0)
    v_mfma_f32_16x16x32_bf16 v[48:51], v[28:31], v[204:207], v[48:51]
    s_waitcnt vmcnt(5)
    ds_read_b128 v[208:211], v24 offset:0
    ds_read_b128 v[212:215], v25 offset:0
    ds_read_b128 v[216:219], v26 offset:0
    ds_read_b128 v[220:223], v27 offset:0
    v_mfma_f32_32x32x16_bf16 v[64:79], v[192:195], v[192:195], v[64:79]
    s_add_u32 m0, s26, 98304
    s_lshr_b32 s61, s25, 5
    buffer_load_dwordx4 v16, s[8:11], s61 offen lds
    v_mfma_f32_32x32x16_bf16 v[64:79], v[196:199], v[196:199], v[64:79]
    s_add_u32 m0, s26, 102400
    s_nop 0
    buffer_load_dwordx4 v17, s[8:11], s61 offen lds
    v_mfma_f32_32x32x16_bf16 v[64:79], v[200:203], v[200:203], v[64:79]
    s_add_u32 m0, s26, 106496
    s_nop 0
    buffer_load_dwordx4 v18, s[8:11], s61 offen lds
    v_mfma_f32_32x32x16_bf16 v[64:79], v[204:207], v[204:207], v[64:79]
    s_add_u32 m0, s26, 110592
    s_nop 0
    buffer_load_dwordx4 v19, s[8:11], s61 offen lds
    s_waitcnt lgkmcnt(3)
    v_mfma_f32_16x16x32_bf16 v[48:51], v[28:31], v[208:211], v[48:51]
    s_waitcnt lgkmcnt(2)
    v_mfma_f32_16x16x32_bf16 v[48:51], v[28:31], v[212:215], v[48:51]
    s_waitcnt lgkmcnt(1)
    v_mfma_f32_16x16x32_bf16 v[48:51], v[28:31], v[216:219], v[48:51]
    s_waitcnt lgkmcnt(0)
    v_mfma_f32_16x16x32_bf16 v[48:51], v[28:31], v[220:223], v[48:51]
    s_mov_b32 m0, s70
    s_mov_b32 s61, s79
    buffer_load_dwordx4 v60, s[8:11], s61 offen offset:0 lds
    s_add_u32 s61, s61, 4080
    buffer_load_dwordx4 v60, s[8:11], s61 offen offset:1040 lds
    s_add_u32 s61, s61, 4080
    buffer_load_dwordx4 v60, s[8:11], s61 offen offset:2080 lds
    s_add_u32 s61, s61, 4080
    buffer_load_dwordx4 v60, s[8:11], s61 offen offset:3120 lds
    s_waitcnt vmcnt(12)
    v_cmp_ne_u64 vcc, s[58:59], v[0:1]
    s_nop 0
    s_cbranch_vccnz L_p2_retry
L_p2_ok:
    s_barrier
    s_add_u32 m0, s26, 0
    s_nop 0
    buffer_load_dwordx4 v3, s[4:7], s16 offen sc1 lds
    s_add_u32 m0, s26, 4096
    s_nop 0
    buffer_load_dwordx4 v3, s[4:7], s17 offen sc1 lds
    s_add_u32 m0, s26, 8192
    s_nop 0
    buffer_load_dwordx4 v3, s[4:7], s18 offen sc1 lds
    s_add_u32 m0, s26, 12288
    s_nop 0
    buffer_load_dwordx4 v3, s[4:7], s19 offen sc1 lds
    s_add_u32 m0, s26, 16384
    s_nop 0
    buffer_load_dwordx4 v3, s[4:7], s20 offen sc1 lds
    s_add_u32 m0, s26, 20480
    s_nop 0
    buffer_load_dwordx4 v3, s[4:7], s21 offen sc1 lds
    s_waitcnt vmcnt(14)
    ds_read_b128 v[224:227], v24 offset:16384
    ds_read_b128 v[228:231], v25 offset:16384
    ds_read_b128 v[232:235], v26 offset:16384
    ds_read_b128 v[236:239], v27 offset:16384
    v_mfma_f32_32x32x16_bf16 v[64:79], v[208:211], v[208:211], v[64:79]
    v_mfma_f32_32x32x16_bf16 v[64:79], v[212:215], v[212:215], v[64:79]
    v_mfma_f32_32x32x16_bf16 v[64:79], v[216:219], v[216:219], v[64:79]
    v_mfma_f32_32x32x16_bf16 v[64:79], v[220:223], v[220:223], v[64:79]
    s_waitcnt lgkmcnt(3)
    v_mfma_f32_16x16x32_bf16 v[48:51], v[28:31], v[224:227], v[48:51]
    s_waitcnt lgkmcnt(2)
    v_mfma_f32_16x16x32_bf16 v[48:51], v[28:31], v[228:231], v[48:51]
    s_waitcnt lgkmcnt(1)
    v_mfma_f32_16x16x32_bf16 v[48:51], v[28:31], v[232:235], v[48:51]
    s_waitcnt lgkmcnt(0)
    v_mfma_f32_16x16x32_bf16 v[48:51], v[28:31], v[236:239], v[48:51]
    s_waitcnt vmcnt(10)
    ds_read_b128 v[240:243], v24 offset:32768
    ds_read_b128 v[244:247], v25 offset:32768
    ds_read_b128 v[248:251], v26 offset:32768
    ds_read_b128 v[252:255], v27 offset:32768
    v_mfma_f32_32x32x16_bf16 v[64:79], v[224:227], v[224:227], v[64:79]
    v_mfma_f32_32x32x16_bf16 v[64:79], v[228:231], v[228:231], v[64:79]
    v_mfma_f32_32x32x16_bf16 v[64:79], v[232:235], v[232:235], v[64:79]
    v_mfma_f32_32x32x16_bf16 v[64:79], v[236:239], v[236:239], v[64:79]
    s_waitcnt lgkmcnt(3)
    v_mfma_f32_16x16x32_bf16 v[48:51], v[28:31], v[240:243], v[48:51]
    s_waitcnt lgkmcnt(2)
    v_mfma_f32_16x16x32_bf16 v[48:51], v[28:31], v[244:247], v[48:51]
    s_waitcnt lgkmcnt(1)
    v_mfma_f32_16x16x32_bf16 v[48:51], v[28:31], v[248:251], v[48:51]
    s_waitcnt lgkmcnt(0)
    v_mfma_f32_16x16x32_bf16 v[48:51], v[28:31], v[252:255], v[48:51]
L_join:
    v_mov_b32 v0, v62
    v_mov_b32 v1, v63
    s_nop 5
    v_mul_f32 v5, 0x3acccccd, v48
    v_mfma_f32_32x32x16_bf16 v[64:79], v[240:243], v[240:243], v[64:79]
    v_cvt_pk_bf16_f32 v32, v5, v5
    v_lshlrev_b32 v32, 16, v32
    v_xor_b32 v32, 0x80000000, v32
    v_mul_f32 v5, v5, v5
    v_mov_b32 v33, v32
    v_mov_b32 v34, v32
    v_mfma_f32_32x32x16_bf16 v[64:79], v[244:247], v[244:247], v[64:79]
    v_mov_b32 v35, v32
    v_mov_b32 v36, v32
    v_mov_b32 v37, v32
    v_mov_b32 v38, v32
    v_mov_b32 v39, v32
    v_mov_b32 v40, v32
    v_mfma_f32_32x32x16_bf16 v[64:79], v[248:251], v[248:251], v[64:79]
    v_mov_b32 v41, v32
    v_mov_b32 v42, v32
    v_mov_b32 v43, v32
    v_mov_b32 v44, v32
    v_mov_b32 v45, v32
    v_mov_b32 v46, v32
    v_mfma_f32_32x32x16_bf16 v[64:79], v[252:255], v[252:255], v[64:79]
    v_mov_b32 v47, v32
    s_nop 1
    v_mfma_f32_32x32x16_bf16 v[48:63], a[88:91], v[96:99], v[32:47]
    s_add_u32 m0, s26, 24576
    s_nop 0
    buffer_load_dwordx4 v3, s[4:7], s22 offen sc1 lds
    s_add_u32 m0, s26, 28672
    v_mfma_f32_32x32x16_bf16 v[80:95], a[88:91], v[104:107], v[32:47]
    buffer_load_dwordx4 v3, s[4:7], s23 offen sc1 lds
    v_mfma_f32_32x32x16_bf16 v[48:63], a[60:63], v[100:103], v[48:63]
    buffer_store_dwordx4 a[92:95], v2, s[4:7], s28 offen sc1
    s_add_u32 s28, s28, s29
    v_mfma_f32_32x32x16_bf16 v[16:31], a[88:91], v[112:115], v[32:47]
    buffer_store_dwordx4 a[96:99], v2, s[4:7], s28 offen sc1
    s_add_u32 s28, s28, s29
    v_mfma_f32_32x32x16_bf16 v[80:95], a[60:63], v[108:111], v[80:95]
    s_nop 5
    v_cvt_pk_bf16_f32 v96, v48, v49
    v_cvt_pk_bf16_f32 v97, v50, v51
    v_cvt_pk_bf16_f32 v98, v52, v53
    v_cvt_pk_bf16_f32 v99, v54, v55
    v_cvt_pk_bf16_f32 v100, v56, v57
    v_cvt_pk_bf16_f32 v101, v58, v59
    v_cvt_pk_bf16_f32 v102, v60, v61
    v_cvt_pk_bf16_f32 v103, v62, v63
    v_mfma_f32_32x32x16_bf16 v[48:63], a[88:91], v[120:123], v[32:47]
    buffer_store_dwordx4 a[100:103], v2, s[4:7], s28 offen sc1
    s_add_u32 s28, s28, s29
    v_mfma_f32_32x32x16_bf16 v[16:31], a[60:63], v[116:119], v[16:31]
    v_cvt_pk_bf16_f32 v104, v80, v81
    v_cvt_pk_bf16_f32 v105, v82, v83
    v_cvt_pk_bf16_f32 v106, v84, v85
    v_cvt_pk_bf16_f32 v107, v86, v87
    v_cvt_pk_bf16_f32 v108, v88, v89
    v_cvt_pk_bf16_f32 v109, v90, v91
    v_cvt_pk_bf16_f32 v110, v92, v93
    v_cvt_pk_bf16_f32 v111, v94, v95
    v_mfma_f32_32x32x16_bf16 v[80:95], a[88:91], v[128:131], v[32:47]
    buffer_store_dwordx4 a[104:107], v2, s[4:7], s28 offen sc1
    s_add_u32 s28, s28, s29
    v_mfma_f32_32x32x16_bf16 v[48:63], a[60:63], v[124:127], v[48:63]
    v_cvt_pk_bf16_f32 v112, v16, v17
    v_cvt_pk_bf16_f32 v113, v18, v19
    v_cvt_pk_bf16_f32 v114, v20, v21
    v_cvt_pk_bf16_f32 v115, v22, v23
    v_cvt_pk_bf16_f32 v116, v24, v25
    v_cvt_pk_bf16_f32 v117, v26, v27
    v_cvt_pk_bf16_f32 v118, v28, v29
    v_cvt_pk_bf16_f32 v119, v30, v31
    v_mfma_f32_32x32x16_bf16 v[16:31], a[88:91], v[136:139], v[32:47]
    buffer_store_dwordx4 a[108:111], v0, s[4:7], s28 offen sc1
    s_add_u32 s28, s28, s29
    v_mfma_f32_32x32x16_bf16 v[80:95], a[60:63], v[132:135], v[80:95]
    v_cvt_pk_bf16_f32 v120, v48, v49
    v_cvt_pk_bf16_f32 v121, v50, v51
    v_cvt_pk_bf16_f32 v122, v52, v53
    v_cvt_pk_bf16_f32 v123, v54, v55
    v_cvt_pk_bf16_f32 v124, v56, v57
    v_cvt_pk_bf16_f32 v125, v58, v59
    v_cvt_pk_bf16_f32 v126, v60, v61
    v_cvt_pk_bf16_f32 v127, v62, v63
    v_mfma_f32_32x32x16_bf16 v[48:63], a[88:91], v[144:147], v[32:47]
    buffer_store_dwordx4 a[112:115], v1, s[4:7], s28 offen sc1
    s_add_u32 s28, s28, s29
    v_mfma_f32_32x32x16_bf16 v[16:31], a[60:63], v[140:143], v[16:31]
    v_cvt_pk_bf16_f32 v128, v80, v81
    v_cvt_pk_bf16_f32 v129, v82, v83
    v_cvt_pk_bf16_f32 v130, v84, v85
    v_cvt_pk_bf16_f32 v131, v86, v87
    v_cvt_pk_bf16_f32 v132, v88, v89
    v_cvt_pk_bf16_f32 v133, v90, v91
    v_cvt_pk_bf16_f32 v134, v92, v93
    v_cvt_pk_bf16_f32 v135, v94, v95
    v_mfma_f32_32x32x16_bf16 v[80:95], a[88:91], v[152:155], v[32:47]
    buffer_store_dwordx4 a[116:119], v1, s[4:7], s28 offen sc1
    s_add_u32 s28, s28, s29
    v_mfma_f32_32x32x16_bf16 v[48:63], a[60:63], v[148:151], v[48:63]
    v_cvt_pk_bf16_f32 v136, v16, v17
    v_cvt_pk_bf16_f32 v137, v18, v19
    v_cvt_pk_bf16_f32 v138, v20, v21
    v_cvt_pk_bf16_f32 v139, v22, v23
    v_cvt_pk_bf16_f32 v140, v24, v25
    v_cvt_pk_bf16_f32 v141, v26, v27
    v_cvt_pk_bf16_f32 v142, v28, v29
    v_cvt_pk_bf16_f32 v143, v30, v31
    v_mfma_f32_32x32x16_bf16 v[16:31], a[88:91], v[160:163], v[32:47]
    buffer_store_dwordx4 a[120:123], v1, s[4:7], s28 offen sc1
    s_add_u32 s28, s28, s29
    v_mfma_f32_32x32x16_bf16 v[80:95], a[60:63], v[156:159], v[80:95]
    v_cvt_pk_bf16_f32 v144, v48, v49
    v_cvt_pk_bf16_f32 v145, v50, v51
    v_cvt_pk_bf16_f32 v146, v52, v53
    v_cvt_pk_bf16_f32 v147, v54, v55
    v_cvt_pk_bf16_f32 v148, v56, v57
    v_cvt_pk_bf16_f32 v149, v58, v59
    v_cvt_pk_bf16_f32 v150, v60, v61
    v_cvt_pk_bf16_f32 v151, v62, v63
    v_mfma_f32_32x32x16_bf16 v[48:63], a[88:91], v[168:171], v[32:47]
    buffer_store_dwordx4 a[124:127], v1, s[4:7], s28 offen sc1
    s_add_u32 s28, s28, s29
    v_mfma_f32_32x32x16_bf16 v[16:31], a[60:63], v[164:167], v[16:31]
    v_cvt_pk_bf16_f32 v152, v80, v81
    v_cvt_pk_bf16_f32 v153, v82, v83
    v_cvt_pk_bf16_f32 v154, v84, v85
    v_cvt_pk_bf16_f32 v155, v86, v87
    v_cvt_pk_bf16_f32 v156, v88, v89
    v_cvt_pk_bf16_f32 v157, v90, v91
    v_cvt_pk_bf16_f32 v158, v92, v93
    v_cvt_pk_bf16_f32 v159, v94, v95
    v_mfma_f32_32x32x16_bf16 v[80:95], a[88:91], v[176:179], v[32:47]
    buffer_store_dwordx4 a[128:131], v1, s[4:7], s28 offen sc1
    s_add_u32 s28, s28, s29
    s_nop 0
    v_cvt_pk_bf16_f32 v160, v16, v17
    v_cvt_pk_bf16_f32 v161, v18, v19
    v_mfma_f32_32x32x16_bf16 v[48:63], a[60:63], v[172:175], v[48:63]
    v_cvt_pk_bf16_f32 v162, v20, v21
    v_cvt_pk_bf16_f32 v163, v22, v23
    v_cvt_pk_bf16_f32 v164, v24, v25
    v_cvt_pk_bf16_f32 v165, v26, v27
    v_cvt_pk_bf16_f32 v166, v28, v29
    v_cvt_pk_bf16_f32 v167, v30, v31
    v_mfma_f32_32x32x16_bf16 v[16:31], a[88:91], v[184:187], v[32:47]
    s_nop 4
    v_cvt_pk_bf16_f32 v168, v48, v49
    v_cvt_pk_bf16_f32 v169, v50, v51
    v_mfma_f32_32x32x16_bf16 v[80:95], a[60:63], v[180:183], v[80:95]
    v_cvt_pk_bf16_f32 v170, v52, v53
    v_cvt_pk_bf16_f32 v171, v54, v55
    v_cvt_pk_bf16_f32 v172, v56, v57
    v_cvt_pk_bf16_f32 v173, v58, v59
    v_cvt_pk_bf16_f32 v174, v60, v61
    v_cvt_pk_bf16_f32 v175, v62, v63
    v_mfma_f32_32x32x16_bf16 v[48:63], a[88:91], v[192:195], v[32:47]
    s_nop 4
    v_cvt_pk_bf16_f32 v176, v80, v81
    v_cvt_pk_bf16_f32 v177, v82, v83
    v_mfma_f32_32x32x16_bf16 v[16:31], a[60:63], v[188:191], v[16:31]
    v_cvt_pk_bf16_f32 v178, v84, v85
    v_cvt_pk_bf16_f32 v179, v86, v87
    v_cvt_pk_bf16_f32 v180, v88, v89
    v_cvt_pk_bf16_f32 v181, v90, v91
    v_cvt_pk_bf16_f32 v182, v92, v93
    v_cvt_pk_bf16_f32 v183, v94, v95
    v_mfma_f32_32x32x16_bf16 v[80:95], a[88:91], v[200:203], v[32:47]
    s_nop 4
    v_cvt_pk_bf16_f32 v184, v16, v17
    v_cvt_pk_bf16_f32 v185, v18, v19
    v_mfma_f32_32x32x16_bf16 v[48:63], a[60:63], v[196:199], v[48:63]
    v_cvt_pk_bf16_f32 v186, v20, v21
    v_cvt_pk_bf16_f32 v187, v22, v23
    v_cvt_pk_bf16_f32 v188, v24, v25
    v_cvt_pk_bf16_f32 v189, v26, v27
    v_cvt_pk_bf16_f32 v190, v28, v29
    v_cvt_pk_bf16_f32 v191, v30, v31
    v_mfma_f32_32x32x16_bf16 v[16:31], a[88:91], v[208:211], v[32:47]
    s_nop 4
    v_cvt_pk_bf16_f32 v192, v48, v49
    v_cvt_pk_bf16_f32 v193, v50, v51
    v_mfma_f32_32x32x16_bf16 v[80:95], a[60:63], v[204:207], v[80:95]
    v_cvt_pk_bf16_f32 v194, v52, v53
    v_cvt_pk_bf16_f32 v195, v54, v55
    v_cvt_pk_bf16_f32 v196, v56, v57
    v_cvt_pk_bf16_f32 v197, v58, v59
    v_cvt_pk_bf16_f32 v198, v60, v61
    v_cvt_pk_bf16_f32 v199, v62, v63
    v_mfma_f32_32x32x16_bf16 v[48:63], a[88:91], v[216:219], v[32:47]
    s_nop 4
    v_cvt_pk_bf16_f32 v200, v80, v81
    v_cvt_pk_bf16_f32 v201, v82, v83
    v_mfma_f32_32x32x16_bf16 v[16:31], a[60:63], v[212:215], v[16:31]
    v_cvt_pk_bf16_f32 v202, v84, v85
    v_cvt_pk_bf16_f32 v203, v86, v87
    v_cvt_pk_bf16_f32 v204, v88, v89
    v_cvt_pk_bf16_f32 v205, v90, v91
    v_cvt_pk_bf16_f32 v206, v92, v93
    v_cvt_pk_bf16_f32 v207, v94, v95
    v_mfma_f32_32x32x16_bf16 v[80:95], a[88:91], v[224:227], v[32:47]
    s_nop 4
    v_cvt_pk_bf16_f32 v208, v16, v17
    v_cvt_pk_bf16_f32 v209, v18, v19
    v_mfma_f32_32x32x16_bf16 v[48:63], a[60:63], v[220:223], v[48:63]
    v_cvt_pk_bf16_f32 v210, v20, v21
    v_cvt_pk_bf16_f32 v211, v22, v23
    v_cvt_pk_bf16_f32 v212, v24, v25
    v_cvt_pk_bf16_f32 v213, v26, v27
    v_cvt_pk_bf16_f32 v214, v28, v29
    v_cvt_pk_bf16_f32 v215, v30, v31
    v_mfma_f32_32x32x16_bf16 v[16:31], a[88:91], v[232:235], v[32:47]
    s_nop 4
    v_cvt_pk_bf16_f32 v216, v48, v49
    v_cvt_pk_bf16_f32 v217, v50, v51
    v_mfma_f32_32x32x16_bf16 v[80:95], a[60:63], v[228:231], v[80:95]
    v_cvt_pk_bf16_f32 v218, v52, v53
    v_cvt_pk_bf16_f32 v219, v54, v55
    v_cvt_pk_bf16_f32 v220, v56, v57
    v_cvt_pk_bf16_f32 v221, v58, v59
    v_cvt_pk_bf16_f32 v222, v60, v61
    v_cvt_pk_bf16_f32 v223, v62, v63
    v_mfma_f32_32x32x16_bf16 v[48:63], a[88:91], v[240:243], v[32:47]
    s_nop 4
    v_cvt_pk_bf16_f32 v224, v80, v81
    v_cvt_pk_bf16_f32 v225, v82, v83
    v_mfma_f32_32x32x16_bf16 v[16:31], a[60:63], v[236:239], v[16:31]
    v_cvt_pk_bf16_f32 v226, v84, v85
    v_cvt_pk_bf16_f32 v227, v86, v87
    v_cvt_pk_bf16_f32 v228, v88, v89
    v_cvt_pk_bf16_f32 v229, v90, v91
    v_cvt_pk_bf16_f32 v230, v92, v93
    v_cvt_pk_bf16_f32 v231, v94, v95
    v_mfma_f32_32x32x16_bf16 v[80:95], a[88:91], v[248:251], v[32:47]
    s_nop 4
    v_cvt_pk_bf16_f32 v232, v16, v17
    v_cvt_pk_bf16_f32 v233, v18, v19
    v_mfma_f32_32x32x16_bf16 v[48:63], a[60:63], v[244:247], v[48:63]
    v_cvt_pk_bf16_f32 v234, v20, v21
    v_cvt_pk_bf16_f32 v235, v22, v23
    v_cvt_pk_bf16_f32 v236, v24, v25
    v_cvt_pk_bf16_f32 v237, v26, v27
    v_cvt_pk_bf16_f32 v238, v28, v29
    v_cvt_pk_bf16_f32 v239, v30, v31
    v_mfma_f32_32x32x16_bf16 v[80:95], a[60:63], v[252:255], v[80:95]
    s_nop 4
    v_cvt_pk_bf16_f32 v240, v48, v49
    v_cvt_pk_bf16_f32 v241, v50, v51
    v_cvt_pk_bf16_f32 v242, v52, v53
    v_cvt_pk_bf16_f32 v243, v54, v55
    v_cvt_pk_bf16_f32 v244, v56, v57
    v_cvt_pk_bf16_f32 v245, v58, v59
    v_cvt_pk_bf16_f32 v246, v60, v61
    v_cvt_pk_bf16_f32 v247, v62, v63
    s_waitcnt vmcnt(16)
    s_barrier
    ds_read_b128 a[0:3], v2 offset:0
    ds_read_b128 a[4:7], v2 offset:1024
    ds_read_b128 a[8:11], v2 offset:2048
    ds_read_b128 a[12:15], v2 offset:3072
    ds_read_b128 a[16:19], v2 offset:4096
    ds_read_b128 a[20:23], v2 offset:5120
    ds_read_b128 a[24:27], v2 offset:6144
    ds_read_b128 a[28:31], v2 offset:7168
    v_cvt_pk_bf16_f32 v248, v80, v81
    v_cvt_pk_bf16_f32 v249, v82, v83
    v_cvt_pk_bf16_f32 v250, v84, v85
    v_cvt_pk_bf16_f32 v251, v86, v87
    v_cvt_pk_bf16_f32 v252, v88, v89
    v_cvt_pk_bf16_f32 v253, v90, v91
    v_cvt_pk_bf16_f32 v254, v92, v93
    v_cvt_pk_bf16_f32 v255, v94, v95
    s_waitcnt lgkmcnt(6)
    v_mfma_f32_32x32x16_bf16 v[16:31], a[0:3], v[96:99], 0
    s_waitcnt vmcnt(14)
    s_barrier
    ds_read_b128 a[0:3], v2 offset:8192
    s_add_u32 m0, s26, 32768
    v_accvgpr_read_b32 v8, a85
    v_mfma_f32_32x32x16_bf16 v[16:31], a[4:7], v[100:103], v[16:31]
    ds_read_b128 a[4:7], v2 offset:9216
    buffer_load_dwordx4 v3, s[4:7], s24 offen sc1 lds
    s_add_u32 m0, s26, 36864
    ds_read_b64_tr_b16 a[32:33], v8 offset:0
    s_waitcnt lgkmcnt(7)
    v_mfma_f32_32x32x16_bf16 v[16:31], a[8:11], v[104:107], v[16:31]
    ds_read_b128 a[8:11], v2 offset:10240
    buffer_load_dwordx4 v3, s[4:7], s25 offen sc1 lds
    s_add_u32 m0, s26, 40960
    v_mfma_f32_32x32x16_bf16 v[16:31], a[12:15], v[108:111], v[16:31]
    ds_read_b128 a[12:15], v2 offset:11264
    v_add_u32 v3, 40960, v3
    buffer_load_dwordx4 v3, s[4:7], s16 offen sc1 lds
    s_add_u32 m0, s26, 45056
    ds_read_b64_tr_b16 a[34:35], v8 offset:160
    s_waitcnt lgkmcnt(8)
    v_mfma_f32_32x32x16_bf16 v[16:31], a[16:19], v[112:115], v[16:31]
    ds_read_b128 a[16:19], v2 offset:12288
    buffer_load_dwordx4 v3, s[4:7], s17 offen sc1 lds
    s_add_u32 m0, s26, 49152
    v_mfma_f32_32x32x16_bf16 v[16:31], a[20:23], v[116:119], v[16:31]
    ds_read_b128 a[20:23], v2 offset:13312
    buffer_load_dwordx4 v3, s[4:7], s18 offen sc1 lds
    s_add_u32 m0, s26, 53248
    ds_read_b64_tr_b16 a[36:37], v8 offset:320
    s_waitcnt lgkmcnt(9)
    v_mfma_f32_32x32x16_bf16 v[16:31], a[24:27], v[120:123], v[16:31]
    ds_read_b128 a[24:27], v2 offset:14336
    buffer_load_dwordx4 v3, s[4:7], s19 offen sc1 lds
    s_add_u32 m0, s26, 57344
    v_mfma_f32_32x32x16_bf16 v[16:31], a[28:31], v[124:127], v[16:31]
    ds_read_b128 a[28:31], v2 offset:15360
    buffer_load_dwordx4 v3, s[4:7], s20 offen sc1 lds
    s_add_u32 m0, s26, 61440
    ds_read_b64_tr_b16 a[38:39], v8 offset:480
    s_waitcnt lgkmcnt(10)
    v_mfma_f32_32x32x16_bf16 v[16:31], a[0:3], v[128:131], v[16:31]
    s_waitcnt vmcnt(19)
    s_barrier
    ds_read_b128 a[0:3], v2 offset:16384
    buffer_load_dwordx4 v3, s[4:7], s21 offen sc1 lds
    v_mfma_f32_32x32x16_bf16 v[16:31], a[4:7], v[132:135], v[16:31]
    ds_read_b128 a[4:7], v2 offset:17408
    s_add_u32 m0, s26, 0
    s_nop 0
    buffer_load_dwordx4 v3, s[4:7], s22 offen sc1 lds
    s_add_u32 m0, s26, 4096
    s_waitcnt lgkmcnt(9)
    v_mfma_f32_32x32x16_bf16 v[16:31], a[8:11], v[136:139], v[16:31]
    ds_read_b128 a[8:11], v2 offset:18432
    buffer_load_dwordx4 v3, s[4:7], s23 offen sc1 lds
    ds_read_b64_tr_b16 a[40:41], v8 offset:640
    v_mfma_f32_32x32x16_bf16 v[16:31], a[12:15], v[140:143], v[16:31]
    ds_read_b128 a[12:15], v2 offset:19456
    v_accvgpr_write_b32 a42, 0
    v_accvgpr_write_b32 a43, 0
    ds_read_b64_tr_b16 a[44:45], v8 offset:32
    ds_read_b64_tr_b16 a[46:47], v8 offset:192
    ds_read_b64_tr_b16 a[48:49], v8 offset:352
    s_waitcnt lgkmcnt(12)
    v_mfma_f32_32x32x16_bf16 v[16:31], a[16:19], v[144:147], v[16:31]
    ds_read_b128 a[16:19], v2 offset:20480
    ds_read_b64_tr_b16 a[50:51], v8 offset:512
    ds_read_b64_tr_b16 a[52:53], v8 offset:672
    v_accvgpr_write_b32 a54, 0
    v_accvgpr_write_b32 a55, 0
    v_mfma_f32_32x32x16_bf16 v[16:31], a[20:23], v[148:151], v[16:31]
    ds_read_b128 a[20:23], v2 offset:21504
    s_and_b32 s62, s53, 8
    s_lshl_b32 s63, s54, 1
    s_add_u32 s62, s62, s63
    s_add_u32 s63, s56, s52
    s_and_b32 s63, s63, 1
    s_waitcnt lgkmcnt(13)
    v_mfma_f32_32x32x16_bf16 v[16:31], a[24:27], v[152:155], v[16:31]
    ds_read_b128 a[24:27], v2 offset:22528
    s_add_u32 s37, s62, s63
    s_mul_i32 s61, s56, 348160
    s_add_u32 s61, s61, 5111808
    s_mul_i32 s62, s37, 5120
    v_mfma_f32_32x32x16_bf16 v[16:31], a[28:31], v[156:159], v[16:31]
    ds_read_b128 a[28:31], v2 offset:23552
    s_add_u32 s66, s61, s62
    s_xor_b32 s62, s37, 1
    s_mul_i32 s62, s62, 5120
    s_add_u32 s67, s61, s62
    s_lshr_b32 s62, s37, 2
    s_waitcnt lgkmcnt(12)
    v_mfma_f32_32x32x16_bf16 v[16:31], a[0:3], v[160:163], v[16:31]
    s_waitcnt vmcnt(20)
    s_barrier
    ds_read_b128 a[0:3], v2 offset:24576
    s_add_u32 m0, s26, 8192
    s_mul_i32 s62, s62, 5120
    v_mfma_f32_32x32x16_bf16 v[16:31], a[4:7], v[164:167], v[16:31]
    ds_read_b128 a[4:7], v2 offset:25600
    buffer_load_dwordx4 v3, s[4:7], s24 offen sc1 lds
    s_add_u32 m0, s26, 12288
    s_add_u32 s68, s61, s62
    s_waitcnt lgkmcnt(11)
    v_mfma_f32_32x32x16_bf16 v[16:31], a[8:11], v[168:171], v[16:31]
    ds_read_b128 a[8:11], v2 offset:26624
    buffer_load_dwordx4 v3, s[4:7], s25 offen sc1 lds
    v_and_b32 v9, 1, v10
    v_mfma_f32_32x32x16_bf16 v[16:31], a[12:15], v[172:175], v[16:31]
    ds_read_b128 a[12:15], v2 offset:27648
    v_cmp_ne_u32 s[62:63], 0, v9
    s_nop 1
    v_cndmask_b32 v64, v64, v65, s[62:63]
    v_cndmask_b32 v65, v66, v67, s[62:63]
    v_cndmask_b32 v66, v68, v69, s[62:63]
    v_cndmask_b32 v67, v70, v71, s[62:63]
    s_waitcnt lgkmcnt(6)
    v_mfma_f32_32x32x16_bf16 v[16:31], a[16:19], v[176:179], v[16:31]
    ds_read_b128 a[16:19], v2 offset:28672
    v_cndmask_b32 v68, v72, v73, s[62:63]
    v_cndmask_b32 v69, v74, v75, s[62:63]
    v_cndmask_b32 v70, v76, v77, s[62:63]
    v_cndmask_b32 v71, v78, v79, s[62:63]
    v_mfma_f32_32x32x16_bf16 v[16:31], a[20:23], v[180:183], v[16:31]
    ds_read_b128 a[20:23], v2 offset:29696
    v_and_b32 v9, 2, v10
    v_cmp_ne_u32 s[62:63], 0, v9
    s_nop 1
    v_cndmask_b32 v64, v64, v65, s[62:63]
    v_cndmask_b32 v65, v66, v67, s[62:63]
    v_cndmask_b32 v66, v68, v69, s[62:63]
    s_waitcnt lgkmcnt(6)
    v_mfma_f32_32x32x16_bf16 v[16:31], a[24:27], v[184:187], v[16:31]
    ds_read_b128 a[24:27], v2 offset:30720
    v_cndmask_b32 v67, v70, v71, s[62:63]
    v_and_b32 v9, 8, v10
    v_cmp_ne_u32 s[62:63], 0, v9
    s_nop 1
    v_cndmask_b32 v64, v64, v65, s[62:63]
    v_mfma_f32_32x32x16_bf16 v[16:31], a[28:31], v[188:191], v[16:31]
    ds_read_b128 a[28:31], v2 offset:31744
    v_cndmask_b32 v65, v66, v67, s[62:63]
    v_and_b32 v9, 16, v10
    v_cmp_ne_u32 s[62:63], 0, v9
    s_nop 1
    v_cndmask_b32 v4, v64, v65, s[62:63]
    v_bfe_u32 v9, v10, 2, 1
    s_waitcnt lgkmcnt(6)
    v_mfma_f32_32x32x16_bf16 v[16:31], a[0:3], v[192:195], v[16:31]
    s_waitcnt vmcnt(10)
    s_barrier
    ds_read_b128 a[0:3], v2 offset:32768
    s_add_u32 m0, s26, 16384
    v_cmp_eq_u32 s[62:63], v9, v11
    v_mfma_f32_32x32x16_bf16 v[16:31], a[4:7], v[196:199], v[16:31]
    ds_read_b128 a[4:7], v2 offset:33792
    v_add_u32 v3, 40960, v3
    buffer_load_dwordx4 v3, s[4:7], s16 offen sc1 lds
    s_add_u32 m0, s26, 20480
    v_cndmask_b32 v4, 0, v4, s[62:63]
    s_waitcnt lgkmcnt(6)
    v_mfma_f32_32x32x16_bf16 v[16:31], a[8:11], v[200:203], v[16:31]
    ds_read_b128 a[8:11], v2 offset:34816
    buffer_load_dwordx4 v3, s[4:7], s17 offen sc1 lds
    v_mov_b32 v64, v4
    v_mfma_f32_32x32x16_bf16 v[16:31], a[12:15], v[204:207], v[16:31]
    ds_read_b128 a[12:15], v2 offset:35840
    s_bfm_b64 exec, s69, 0
    buffer_store_dwordx4 a[252:255], v2, s[4:7], s34 offen sc1
    s_mov_b64 exec, -1
    s_waitcnt lgkmcnt(6)
    v_mfma_f32_32x32x16_bf16 v[16:31], a[16:19], v[208:211], v[16:31]
    ds_read_b128 a[16:19], v2 offset:36864
    v_mov_b32 v65, v4
    s_nop 1
    v_permlane32_swap_b32 v64, v65
    v_add_f32 v64, v64, v65
    v_mfma_f32_32x32x16_bf16 v[16:31], a[20:23], v[212:215], v[16:31]
    ds_read_b128 a[20:23], v2 offset:37888
    v_mul_f32 v64, 0x3acccccd, v64
    v_sub_f32 v64, v64, v5
    v_max_f32 v64, 0, v64
    v_cvt_pk_bf16_f32 v64, v64, v64
    v_lshlrev_b32 v64, 16, v64
    s_waitcnt lgkmcnt(6)
    v_mfma_f32_32x32x16_bf16 v[16:31], a[24:27], v[216:219], v[16:31]
    ds_read_b128 a[24:27], v2 offset:38912
    v_add_f32 v64, 0x3727c5ac, v64
    v_cvt_pk_bf16_f32 v64, v64, v64
    v_lshlrev_b32 v64, 16, v64
    s_mul_i32 s80, s55, 278528
    v_mfma_f32_32x32x16_bf16 v[16:31], a[28:31], v[220:223], v[16:31]
    ds_read_b128 a[28:31], v2 offset:39936
    v_sqrt_f32 v64, v64
    s_nop 0
    v_cvt_pk_bf16_f32 v64, v64, v64
    v_accvgpr_write_b32 a87, v64
    s_waitcnt lgkmcnt(6)
    v_mfma_f32_32x32x16_bf16 v[16:31], a[0:3], v[224:227], v[16:31]
    s_waitcnt vmcnt(11)
    s_barrier
    ds_read_b128 a[0:3], v2 offset:40960
    s_add_u32 m0, s26, 24576
    v_lshlrev_b32 v64, 16, v64
    v_mfma_f32_32x32x16_bf16 v[16:31], a[4:7], v[228:231], v[16:31]
    ds_read_b128 a[4:7], v2 offset:41984
    buffer_load_dwordx4 v3, s[4:7], s18 offen sc1 lds
    s_add_u32 m0, s26, 28672
    s_add_u32 s80, s80, 7929856
    s_waitcnt lgkmcnt(6)
    v_mfma_f32_32x32x16_bf16 v[16:31], a[8:11], v[232:235], v[16:31]
    ds_read_b128 a[8:11], v2 offset:43008
    buffer_load_dwordx4 v3, s[4:7], s19 offen sc1 lds
    s_xor_b32 s29, s55, 1
    v_mfma_f32_32x32x16_bf16 v[16:31], a[12:15], v[236:239], v[16:31]
    ds_read_b128 a[12:15], v2 offset:44032
    v_rcp_f32 v5, v64
    s_nop 0
    v_mul_f32 v4, 1069066811, v5
    s_mul_i32 s29, s29, 278528
    s_waitcnt lgkmcnt(6)
    v_mfma_f32_32x32x16_bf16 v[16:31], a[16:19], v[240:243], v[16:31]
    ds_read_b128 a[16:19], v2 offset:45056
    s_add_u32 s29, s29, 7929856
    s_lshl_b32 s81, s37, 12
    s_add_u32 s72, s29, s81
    s_add_u32 s74, s80, s81
    v_mfma_f32_32x32x16_bf16 v[16:31], a[20:23], v[244:247], v[16:31]
    ds_read_b128 a[20:23], v2 offset:46080
    s_xor_b32 s81, s81, 4096
    s_add_u32 s73, s29, s81
    s_add_u32 s75, s80, s81
    s_lshr_b32 s81, s37, 2
    s_lshl_b32 s77, s81, 13
    s_waitcnt lgkmcnt(6)
    v_mfma_f32_32x32x16_bf16 v[16:31], a[24:27], v[248:251], v[16:31]
    ds_read_b128 a[24:27], v2 offset:47104
    s_lshl_b32 s81, s81, 12
    s_add_u32 s81, s81, 262144
    s_add_u32 s76, s29, s81
    s_add_u32 s78, s80, s81
    v_mfma_f32_32x32x16_bf16 v[16:31], a[28:31], v[252:255], v[16:31]
    ds_read_b128 a[28:31], v2 offset:48128
    s_lshl_b32 s81, s52, 15
    s_add_u32 s77, s77, s81
    s_and_b32 s81, s26, 1024
    s_add_u32 s77, s77, s81
    s_add_u32 s77, s77, 18022400
    s_waitcnt lgkmcnt(6)
    v_mfma_f32_32x32x16_bf16 v[32:47], a[0:3], v[96:99], 0
    s_waitcnt vmcnt(11)
    s_barrier
    ds_read_b128 a[0:3], v2 offset:49152
    s_add_u32 m0, s26, 32768
    s_add_u32 s80, s30, 196608
    v_mfma_f32_32x32x16_bf16 v[32:47], a[4:7], v[100:103], v[32:47]
    ds_read_b128 a[4:7], v2 offset:50176
    buffer_load_dwordx4 v3, s[4:7], s20 offen sc1 lds
    s_add_u32 m0, s26, 36864
    s_lshl_b32 s81, s55, 17
    s_waitcnt lgkmcnt(6)
    v_mfma_f32_32x32x16_bf16 v[32:47], a[8:11], v[104:107], v[32:47]
    ds_read_b128 a[8:11], v2 offset:51200
    buffer_load_dwordx4 v3, s[4:7], s21 offen sc1 lds
    v_cvt_pk_bf16_f32 v80, v16, v17
    v_mfma_f32_32x32x16_bf16 v[32:47], a[12:15], v[108:111], v[32:47]
    ds_read_b128 a[12:15], v2 offset:52224
    v_cvt_pk_bf16_f32 v81, v18, v19
    v_cvt_pk_bf16_f32 v82, v20, v21
    v_cvt_pk_bf16_f32 v83, v22, v23
    v_cvt_pk_bf16_f32 v84, v24, v25
    v_cvt_pk_bf16_f32 v85, v26, v27
    s_waitcnt lgkmcnt(6)
    v_mfma_f32_32x32x16_bf16 v[32:47], a[16:19], v[112:115], v[32:47]
    ds_read_b128 a[16:19], v2 offset:53248
    v_cvt_pk_bf16_f32 v86, v28, v29
    v_cvt_pk_bf16_f32 v87, v30, v31
    s_lshl_b32 s29, s56, 14
    s_add_u32 s81, s81, s29
    v_mfma_f32_32x32x16_bf16 v[32:47], a[20:23], v[116:119], v[32:47]
    ds_read_b128 a[20:23], v2 offset:54272
    s_lshl_b32 s29, s54, 12
    s_add_u32 s81, s81, s29
    s_xor_b32 s29, s81, 131072
    s_add_u32 s81, s81, 18546688
    s_add_u32 s29, s29, 18546688
    s_waitcnt lgkmcnt(6)
    v_mfma_f32_32x32x16_bf16 v[32:47], a[24:27], v[120:123], v[32:47]
    ds_read_b128 a[24:27], v2 offset:55296
    v_mfma_f32_32x32x16_bf16 v[32:47], a[28:31], v[124:127], v[32:47]
    ds_read_b128 a[28:31], v2 offset:56320
    s_waitcnt lgkmcnt(6)
    v_mfma_f32_32x32x16_bf16 v[32:47], a[0:3], v[128:131], v[32:47]
    s_waitcnt vmcnt(11)
    s_barrier
    ds_read_b128 a[0:3], v2 offset:57344
    s_add_u32 m0, s26, 40960
    v_mfma_f32_32x32x16_bf16 v[32:47], a[4:7], v[132:135], v[32:47]
    ds_read_b128 a[4:7], v2 offset:58368
    buffer_load_dwordx4 v3, s[4:7], s22 offen sc1 lds
    s_add_u32 m0, s26, 45056
    s_waitcnt lgkmcnt(6)
    v_mfma_f32_32x32x16_bf16 v[32:47], a[8:11], v[136:139], v[32:47]
    ds_read_b128 a[8:11], v2 offset:59392
    buffer_load_dwordx4 v3, s[4:7], s23 offen sc1 lds
    v_mfma_f32_32x32x16_bf16 v[32:47], a[12:15], v[140:143], v[32:47]
    ds_read_b128 a[12:15], v2 offset:60416
    s_waitcnt lgkmcnt(6)
    v_mfma_f32_32x32x16_bf16 v[32:47], a[16:19], v[144:147], v[32:47]
    ds_read_b128 a[16:19], v2 offset:61440
    v_mfma_f32_32x32x16_bf16 v[32:47], a[20:23], v[148:151], v[32:47]
    ds_read_b128 a[20:23], v2 offset:62464
    s_waitcnt lgkmcnt(6)
    v_mfma_f32_32x32x16_bf16 v[32:47], a[24:27], v[152:155], v[32:47]
    ds_read_b128 a[24:27], v2 offset:63488
    v_mfma_f32_32x32x16_bf16 v[32:47], a[28:31], v[156:159], v[32:47]
    ds_read_b128 a[28:31], v2 offset:64512
    s_waitcnt lgkmcnt(6)
    v_mfma_f32_32x32x16_bf16 v[32:47], a[0:3], v[160:163], v[32:47]
    s_waitcnt vmcnt(11)
    s_barrier
    ds_read_b128 a[0:3], v2 offset:0
    s_add_u32 m0, s26, 49152
    v_mfma_f32_32x32x16_bf16 v[32:47], a[4:7], v[164:167], v[32:47]
    ds_read_b128 a[4:7], v2 offset:1024
    buffer_load_dwordx4 v3, s[4:7], s24 offen sc1 lds
    s_add_u32 m0, s26, 53248
    s_waitcnt lgkmcnt(6)
    v_mfma_f32_32x32x16_bf16 v[32:47], a[8:11], v[168:171], v[32:47]
    ds_read_b128 a[8:11], v2 offset:2048
    buffer_load_dwordx4 v3, s[4:7], s25 offen sc1 lds
    v_mfma_f32_32x32x16_bf16 v[32:47], a[12:15], v[172:175], v[32:47]
    ds_read_b128 a[12:15], v2 offset:3072
    s_waitcnt lgkmcnt(6)
    v_mfma_f32_32x32x16_bf16 v[32:47], a[16:19], v[176:179], v[32:47]
    ds_read_b128 a[16:19], v2 offset:4096
    v_mfma_f32_32x32x16_bf16 v[32:47], a[20:23], v[180:183], v[32:47]
    ds_read_b128 a[20:23], v2 offset:5120
    s_waitcnt lgkmcnt(6)
    v_mfma_f32_32x32x16_bf16 v[32:47], a[24:27], v[184:187], v[32:47]
    ds_read_b128 a[24:27], v2 offset:6144
    v_mfma_f32_32x32x16_bf16 v[32:47], a[28:31], v[188:191], v[32:47]
    ds_read_b128 a[28:31], v2 offset:7168
    s_add_u32 s35, s36, 131072
    s_lshl_b32 s36, s56, 14
    s_add_u32 s36, s36, 393216
    s_waitcnt lgkmcnt(6)
    v_mfma_f32_32x32x16_bf16 v[32:47], a[0:3], v[192:195], v[32:47]
    s_waitcnt vmcnt(11)
    s_barrier
    ds_read_b128 a[0:3], v2 offset:8192
    v_mfma_f32_32x32x16_bf16 v[32:47], a[4:7], v[196:199], v[32:47]
    ds_read_b128 a[4:7], v2 offset:9216
    v_min_u32 v88, 144, v2
    v_lshlrev_b32 v88, 3, v88
    buffer_load_dwordx2 v[88:89], v88, s[4:7], s35 offen offset:0 sc1
    s_waitcnt lgkmcnt(6)
    v_mfma_f32_32x32x16_bf16 v[32:47], a[8:11], v[200:203], v[32:47]
    ds_read_b128 a[8:11], v2 offset:10240
    v_mfma_f32_32x32x16_bf16 v[32:47], a[12:15], v[204:207], v[32:47]
    ds_read_b128 a[12:15], v2 offset:11264
    s_and_b32 s71, s37, 14
    v_lshrrev_b32 v90, 5, v2
    v_bfe_u32 v91, v2, 4, 1
    v_lshl_add_u32 v90, v90, 4, v91
    v_add_u32 v90, s71, v90
    s_lshr_b32 s71, s37, 2
    s_add_u32 s71, s71, 64
    v_min_u32 v90, s71, v90
    v_lshlrev_b32 v90, 7, v90
    buffer_load_dwordx2 v[90:91], v90, s[4:7], s36 offen offset:0 sc1
    s_waitcnt lgkmcnt(6)
    v_mfma_f32_32x32x16_bf16 v[32:47], a[16:19], v[208:211], v[32:47]
    ds_read_b128 a[16:19], v2 offset:12288
    v_mfma_f32_32x32x16_bf16 v[32:47], a[20:23], v[212:215], v[32:47]
    ds_read_b128 a[20:23], v2 offset:13312
    s_waitcnt lgkmcnt(6)
    v_mfma_f32_32x32x16_bf16 v[32:47], a[24:27], v[216:219], v[32:47]
    ds_read_b128 a[24:27], v2 offset:14336
    v_mfma_f32_32x32x16_bf16 v[32:47], a[28:31], v[220:223], v[32:47]
    ds_read_b128 a[28:31], v2 offset:15360
    s_waitcnt lgkmcnt(6)
    v_mfma_f32_32x32x16_bf16 v[32:47], a[0:3], v[224:227], v[32:47]
    s_waitcnt vmcnt(11)
    s_barrier
    ds_read_b128 a[0:3], v2 offset:16384
    v_mfma_f32_32x32x16_bf16 v[32:47], a[4:7], v[228:231], v[32:47]
    ds_read_b128 a[4:7], v2 offset:17408
    s_waitcnt lgkmcnt(6)
    v_mfma_f32_32x32x16_bf16 v[32:47], a[8:11], v[232:235], v[32:47]
    ds_read_b128 a[8:11], v2 offset:18432
    v_mfma_f32_32x32x16_bf16 v[32:47], a[12:15], v[236:239], v[32:47]
    ds_read_b128 a[12:15], v2 offset:19456
    s_waitcnt lgkmcnt(6)
    v_mfma_f32_32x32x16_bf16 v[32:47], a[16:19], v[240:243], v[32:47]
    ds_read_b128 a[16:19], v2 offset:20480
    v_mfma_f32_32x32x16_bf16 v[32:47], a[20:23], v[244:247], v[32:47]
    ds_read_b128 a[20:23], v2 offset:21504
    s_waitcnt lgkmcnt(6)
    v_mfma_f32_32x32x16_bf16 v[32:47], a[24:27], v[248:251], v[32:47]
    ds_read_b128 a[24:27], v2 offset:22528
    v_mfma_f32_32x32x16_bf16 v[32:47], a[28:31], v[252:255], v[32:47]
    ds_read_b128 a[28:31], v2 offset:23552
    s_waitcnt lgkmcnt(6)
    v_mfma_f32_32x32x16_bf16 v[16:31], a[0:3], v[96:99], 0
    s_waitcnt vmcnt(8)
    s_barrier
    ds_read_b128 a[0:3], v2 offset:24576
    v_mfma_f32_32x32x16_bf16 v[16:31], a[4:7], v[100:103], v[16:31]
    ds_read_b128 a[4:7], v2 offset:25600
    s_waitcnt lgkmcnt(6)
    v_mfma_f32_32x32x16_bf16 v[16:31], a[8:11], v[104:107], v[16:31]
    ds_read_b128 a[8:11], v2 offset:26624
    s_nop 0
    v_cvt_pk_bf16_f32 v12, v32, v33
    v_cvt_pk_bf16_f32 v13, v34, v35
    v_mfma_f32_32x32x16_bf16 v[48:63], a[32:35], v[80:83], 0
    v_accvgpr_read_b32 v0, a81
    v_cvt_pk_bf16_f32 v36, v36, v37
    v_cvt_pk_bf16_f32 v37, v38, v39
    v_cvt_pk_bf16_f32 v38, v40, v41
    v_cvt_pk_bf16_f32 v39, v42, v43
    v_cvt_pk_bf16_f32 v40, v44, v45
    v_mfma_f32_32x32x16_bf16 v[64:79], a[44:47], v[80:83], 0
    v_cvt_pk_bf16_f32 v41, v46, v47
    ds_write_b128 v0, v[36:39]
    v_mfma_f32_32x32x16_bf16 v[48:63], a[36:39], v[84:87], v[48:63]
    v_mfma_f32_32x32x16_bf16 v[64:79], a[48:51], v[84:87], v[64:79]
    v_mfma_f32_32x32x16_bf16 v[48:63], a[40:43], v[12:15], v[48:63]
    ds_write_b64 v0, v[40:41] offset:16
    v_mfma_f32_32x32x16_bf16 v[64:79], a[52:55], v[12:15], v[64:79]
    v_mfma_f32_32x32x16_bf16 v[16:31], a[12:15], v[108:111], v[16:31]
    ds_read_b128 a[12:15], v2 offset:27648
    s_waitcnt vmcnt(0)
    v_cmp_ne_u64 vcc, s[58:59], v[90:91]
    s_nop 0
    s_cbranch_vccnz L_p3_retry
L_p3_ok:
    v_cmp_ne_u64 vcc, s[58:59], v[88:89]
    s_nop 0
    s_cbranch_vccnz L_p4_retry
L_p4_ok:
    s_waitcnt lgkmcnt(8)
    v_mfma_f32_32x32x16_bf16 v[16:31], a[16:19], v[112:115], v[16:31]
    ds_read_b128 a[16:19], v2 offset:28672
    s_add_u32 m0, s26, 57344
    v_add_u32 v3, 81920, v3
    buffer_load_dwordx4 v3, s[4:7], s16 offen sc1 lds
    s_add_u32 m0, s26, 61440
    s_add_u32 s64, s66, 0
    s_add_u32 s65, s64, 4096
    v_mfma_f32_32x32x16_bf16 v[16:31], a[20:23], v[116:119], v[16:31]
    ds_read_b128 a[20:23], v2 offset:29696
    buffer_load_dwordx4 v3, s[4:7], s17 offen sc1 lds
    s_add_u32 m0, s26, 0
    s_nop 0
    buffer_load_dwordx4 v3, s[4:7], s18 offen sc1 lds
    s_waitcnt lgkmcnt(8)
    v_mfma_f32_32x32x16_bf16 v[16:31], a[24:27], v[120:123], v[16:31]
    ds_read_b128 a[24:27], v2 offset:30720
    s_add_u32 m0, s26, 4096
    s_nop 0
    buffer_load_dwordx4 v3, s[4:7], s19 offen sc1 lds
    s_add_u32 m0, s26, 8192
    v_max3_f32 v8, v48, v49, v50
    v_min3_f32 v10, v48, v49, v50
    v_mfma_f32_32x32x16_bf16 v[16:31], a[28:31], v[124:127], v[16:31]
    ds_read_b128 a[28:31], v2 offset:31744
    buffer_load_dwordx4 v3, s[4:7], s20 offen sc1 lds
    s_add_u32 m0, s26, 12288
    s_nop 0
    buffer_load_dwordx4 v3, s[4:7], s21 offen sc1 lds
    s_waitcnt lgkmcnt(8)
    v_mfma_f32_32x32x16_bf16 v[16:31], a[0:3], v[128:131], v[16:31]
    s_barrier
    ds_read_b128 a[0:3], v2 offset:32768
    s_add_u32 m0, s26, 16384
    s_nop 0
    buffer_load_dwordx4 v3, s[4:7], s22 offen sc1 lds
    s_add_u32 m0, s26, 20480
    v_max3_f32 v9, v51, v52, v53
    v_mfma_f32_32x32x16_bf16 v[16:31], a[4:7], v[132:135], v[16:31]
    ds_read_b128 a[4:7], v2 offset:33792
    buffer_load_dwordx4 v3, s[4:7], s23 offen sc1 lds
    buffer_load_dwordx4 a[92:95], v2, s[4:7], s64 offen offset:0 sc1
    v_min3_f32 v11, v51, v52, v53
    s_waitcnt lgkmcnt(6)
    v_mfma_f32_32x32x16_bf16 v[16:31], a[8:11], v[136:139], v[16:31]
    ds_read_b128 a[8:11], v2 offset:34816
    v_max3_f32 v8, v8, v54, v55
    v_min3_f32 v10, v10, v54, v55
    v_max3_f32 v9, v9, v56, v57
    v_min3_f32 v11, v11, v56, v57
    v_max3_f32 v8, v8, v58, v59
    v_min3_f32 v10, v10, v58, v59
    v_max3_f32 v9, v9, v60, v61
    v_mfma_f32_32x32x16_bf16 v[16:31], a[12:15], v[140:143], v[16:31]
    ds_read_b128 a[12:15], v2 offset:35840
    buffer_load_dwordx4 a[96:99], v2, s[4:7], s64 offen offset:1024 sc1
    v_min3_f32 v11, v11, v60, v61
    v_max3_f32 v8, v8, v62, v63
    v_min3_f32 v10, v10, v62, v63
    v_max3_f32 v9, v9, v64, v65
    v_min3_f32 v11, v11, v64, v65
    s_waitcnt lgkmcnt(6)
    v_mfma_f32_32x32x16_bf16 v[16:31], a[16:19], v[144:147], v[16:31]
    ds_read_b128 a[16:19], v2 offset:36864
    v_max3_f32 v8, v8, v66, v67
    v_min3_f32 v10, v10, v66, v67
    v_max_f32 v8, v8, v9
    v_min_f32 v10, v10, v11
    v_mul_f32 v8, v4, v8
    v_mul_f32 v10, v4, v10
    v_pk_fma_f32 v[68:69], v[48:49], v[4:5], v[10:11] op_sel_hi:[1,0,0] neg_lo:[1,0,0] neg_hi:[1,0,0]
    v_pk_fma_f32 v[48:49], v[48:49], v[4:5], v[8:9] op_sel_hi:[1,0,0] neg_lo:[0,0,1] neg_hi:[0,0,1]
    v_pk_fma_f32 v[70:71], v[50:51], v[4:5], v[10:11] op_sel_hi:[1,0,0] neg_lo:[1,0,0] neg_hi:[1,0,0]
    v_pk_fma_f32 v[50:51], v[50:51], v[4:5], v[8:9] op_sel_hi:[1,0,0] neg_lo:[0,0,1] neg_hi:[0,0,1]
    v_pk_fma_f32 v[72:73], v[52:53], v[4:5], v[10:11] op_sel_hi:[1,0,0] neg_lo:[1,0,0] neg_hi:[1,0,0]
    v_pk_fma_f32 v[52:53], v[52:53], v[4:5], v[8:9] op_sel_hi:[1,0,0] neg_lo:[0,0,1] neg_hi:[0,0,1]
    v_pk_fma_f32 v[74:75], v[54:55], v[4:5], v[10:11] op_sel_hi:[1,0,0] neg_lo:[1,0,0] neg_hi:[1,0,0]
    v_pk_fma_f32 v[54:55], v[54:55], v[4:5], v[8:9] op_sel_hi:[1,0,0] neg_lo:[0,0,1] neg_hi:[0,0,1]
    v_pk_fma_f32 v[76:77], v[56:57], v[4:5], v[10:11] op_sel_hi:[1,0,0] neg_lo:[1,0,0] neg_hi:[1,0,0]
    v_pk_fma_f32 v[56:57], v[56:57], v[4:5], v[8:9] op_sel_hi:[1,0,0] neg_lo:[0,0,1] neg_hi:[0,0,1]
    v_pk_fma_f32 v[78:79], v[58:59], v[4:5], v[10:11] op_sel_hi:[1,0,0] neg_lo:[1,0,0] neg_hi:[1,0,0]
    v_pk_fma_f32 v[58:59], v[58:59], v[4:5], v[8:9] op_sel_hi:[1,0,0] neg_lo:[0,0,1] neg_hi:[0,0,1]
    v_pk_fma_f32 v[80:81], v[60:61], v[4:5], v[10:11] op_sel_hi:[1,0,0] neg_lo:[1,0,0] neg_hi:[1,0,0]
    v_pk_fma_f32 v[60:61], v[60:61], v[4:5], v[8:9] op_sel_hi:[1,0,0] neg_lo:[0,0,1] neg_hi:[0,0,1]
    v_pk_fma_f32 v[82:83], v[62:63], v[4:5], v[10:11] op_sel_hi:[1,0,0] neg_lo:[1,0,0] neg_hi:[1,0,0]
    v_pk_fma_f32 v[62:63], v[62:63], v[4:5], v[8:9] op_sel_hi:[1,0,0] neg_lo:[0,0,1] neg_hi:[0,0,1]
    v_pk_fma_f32 v[84:85], v[64:65], v[4:5], v[10:11] op_sel_hi:[1,0,0] neg_lo:[1,0,0] neg_hi:[1,0,0]
    v_pk_fma_f32 v[64:65], v[64:65], v[4:5], v[8:9] op_sel_hi:[1,0,0] neg_lo:[0,0,1] neg_hi:[0,0,1]
    v_pk_fma_f32 v[86:87], v[66:67], v[4:5], v[10:11] op_sel_hi:[1,0,0] neg_lo:[1,0,0] neg_hi:[1,0,0]
    v_pk_fma_f32 v[66:67], v[66:67], v[4:5], v[8:9] op_sel_hi:[1,0,0] neg_lo:[0,0,1] neg_hi:[0,0,1]
    v_mfma_f32_32x32x16_bf16 v[16:31], a[20:23], v[148:151], v[16:31]
    ds_read_b128 a[20:23], v2 offset:37888
    buffer_load_dwordx4 a[100:103], v2, s[4:7], s64 offen offset:2048 sc1
    v_exp_f32 v68, v68
    v_exp_f32 v48, v48
    s_waitcnt lgkmcnt(6)
    v_mfma_f32_32x32x16_bf16 v[16:31], a[24:27], v[152:155], v[16:31]
    ds_read_b128 a[24:27], v2 offset:38912
    v_exp_f32 v69, v69
    v_exp_f32 v49, v49
    v_exp_f32 v70, v70
    v_mfma_f32_32x32x16_bf16 v[16:31], a[28:31], v[156:159], v[16:31]
    ds_read_b128 a[28:31], v2 offset:39936
    buffer_load_dwordx4 a[104:107], v2, s[4:7], s64 offen offset:3072 sc1
    v_exp_f32 v50, v50
    v_exp_f32 v71, v71
    s_waitcnt lgkmcnt(6)
    v_mfma_f32_32x32x16_bf16 v[16:31], a[0:3], v[160:163], v[16:31]
    s_barrier
    ds_read_b128 a[0:3], v2 offset:40960
    s_add_u32 m0, s26, 24576
    s_nop 0
    buffer_load_dwordx4 v3, s[4:7], s24 offen sc1 lds
    s_add_u32 m0, s26, 28672
    v_mfma_f32_32x32x16_bf16 v[16:31], a[4:7], v[164:167], v[16:31]
    ds_read_b128 a[4:7], v2 offset:41984
    buffer_load_dwordx4 v3, s[4:7], s25 offen sc1 lds
    buffer_load_dwordx4 a[108:111], v2, s[4:7], s65 offen offset:0 sc1
    s_waitcnt lgkmcnt(6)
    v_mfma_f32_32x32x16_bf16 v[16:31], a[8:11], v[168:171], v[16:31]
    ds_read_b128 a[8:11], v2 offset:43008
    v_exp_f32 v51, v51
    v_exp_f32 v72, v72
    v_exp_f32 v52, v52
    v_mfma_f32_32x32x16_bf16 v[16:31], a[12:15], v[172:175], v[16:31]
    ds_read_b128 a[12:15], v2 offset:44032
    s_add_u32 s64, s67, 0
    s_add_u32 s65, s64, 4096
    buffer_load_dwordx4 a[112:115], v2, s[4:7], s64 offen offset:0 sc1
    v_exp_f32 v73, v73
    s_waitcnt lgkmcnt(6)
    v_mfma_f32_32x32x16_bf16 v[16:31], a[16:19], v[176:179], v[16:31]
    ds_read_b128 a[16:19], v2 offset:45056
    v_exp_f32 v53, v53
    v_exp_f32 v74, v74
    v_exp_f32 v54, v54
    v_mfma_f32_32x32x16_bf16 v[16:31], a[20:23], v[180:183], v[16:31]
    ds_read_b128 a[20:23], v2 offset:46080
    buffer_load_dwordx4 a[116:119], v2, s[4:7], s64 offen offset:1024 sc1
    v_exp_f32 v75, v75
    v_exp_f32 v55, v55
    s_waitcnt lgkmcnt(6)
    v_mfma_f32_32x32x16_bf16 v[16:31], a[24:27], v[184:187], v[16:31]
    ds_read_b128 a[24:27], v2 offset:47104
    v_exp_f32 v76, v76
    v_exp_f32 v56, v56
    v_exp_f32 v77, v77
    v_mfma_f32_32x32x16_bf16 v[16:31], a[28:31], v[188:191], v[16:31]
    ds_read_b128 a[28:31], v2 offset:48128
    buffer_load_dwordx4 a[120:123], v2, s[4:7], s64 offen offset:2048 sc1
    v_exp_f32 v57, v57
    v_exp_f32 v78, v78
    s_waitcnt lgkmcnt(6)
    v_mfma_f32_32x32x16_bf16 v[16:31], a[0:3], v[192:195], v[16:31]
    s_barrier
    ds_read_b128 a[0:3], v2 offset:49152
    s_add_u32 m0, s26, 32768
    v_add_u32 v3, 40960, v3
    buffer_load_dwordx4 v3, s[4:7], s16 offen sc1 lds
    s_add_u32 m0, s26, 36864
    v_mfma_f32_32x32x16_bf16 v[16:31], a[4:7], v[196:199], v[16:31]
    ds_read_b128 a[4:7], v2 offset:50176
    buffer_load_dwordx4 v3, s[4:7], s17 offen sc1 lds
    buffer_load_dwordx4 a[124:127], v2, s[4:7], s64 offen offset:3072 sc1
    s_waitcnt lgkmcnt(6)
    v_mfma_f32_32x32x16_bf16 v[16:31], a[8:11], v[200:203], v[16:31]
    ds_read_b128 a[8:11], v2 offset:51200
    v_exp_f32 v58, v58
    v_exp_f32 v79, v79
    v_exp_f32 v59, v59
    v_mfma_f32_32x32x16_bf16 v[16:31], a[12:15], v[204:207], v[16:31]
    ds_read_b128 a[12:15], v2 offset:52224
    buffer_load_dwordx4 a[128:131], v2, s[4:7], s65 offen offset:0 sc1
    v_exp_f32 v80, v80
    v_exp_f32 v60, v60
    s_waitcnt lgkmcnt(6)
    v_mfma_f32_32x32x16_bf16 v[16:31], a[16:19], v[208:211], v[16:31]
    ds_read_b128 a[16:19], v2 offset:53248
    v_exp_f32 v81, v81
    v_exp_f32 v61, v61
    v_exp_f32 v82, v82
    v_mfma_f32_32x32x16_bf16 v[16:31], a[20:23], v[212:215], v[16:31]
    ds_read_b128 a[20:23], v2 offset:54272
    s_add_u32 s64, s66, 81920
    s_add_u32 s65, s64, 4096
    buffer_load_dwordx4 a[132:135], v2, s[4:7], s64 offen offset:0 sc1
    v_exp_f32 v62, v62
    s_waitcnt lgkmcnt(6)
    v_mfma_f32_32x32x16_bf16 v[16:31], a[24:27], v[216:219], v[16:31]
    ds_read_b128 a[24:27], v2 offset:55296
    v_exp_f32 v83, v83
    v_exp_f32 v63, v63
    v_exp_f32 v84, v84
    v_mfma_f32_32x32x16_bf16 v[16:31], a[28:31], v[220:223], v[16:31]
    ds_read_b128 a[28:31], v2 offset:56320
    buffer_load_dwordx4 a[136:139], v2, s[4:7], s64 offen offset:1024 sc1
    v_exp_f32 v64, v64
    v_exp_f32 v85, v85
    s_waitcnt lgkmcnt(6)
    v_mfma_f32_32x32x16_bf16 v[16:31], a[0:3], v[224:227], v[16:31]
    s_waitcnt vmcnt(22)
    s_barrier
    ds_read_b128 a[0:3], v2 offset:57344
    s_add_u32 m0, s26, 40960
    s_nop 0
    buffer_load_dwordx4 v3, s[4:7], s18 offen sc1 lds
    s_add_u32 m0, s26, 45056
    v_mfma_f32_32x32x16_bf16 v[16:31], a[4:7], v[228:231], v[16:31]
    ds_read_b128 a[4:7], v2 offset:58368
    buffer_load_dwordx4 v3, s[4:7], s19 offen sc1 lds
    buffer_load_dwordx4 a[140:143], v2, s[4:7], s64 offen offset:2048 sc1
    s_waitcnt lgkmcnt(6)
    v_mfma_f32_32x32x16_bf16 v[16:31], a[8:11], v[232:235], v[16:31]
    ds_read_b128 a[8:11], v2 offset:59392
    v_exp_f32 v65, v65
    v_exp_f32 v86, v86
    v_exp_f32 v66, v66
    v_mfma_f32_32x32x16_bf16 v[16:31], a[12:15], v[236:239], v[16:31]
    ds_read_b128 a[12:15], v2 offset:60416
    buffer_load_dwordx4 a[144:147], v2, s[4:7], s64 offen offset:3072 sc1
    v_exp_f32 v87, v87
    v_exp_f32 v67, v67
    v_pk_add_f32 v[10:11], v[68:69], v[70:71]
    v_pk_add_f32 v[8:9], v[48:49], v[50:51]
    v_pk_add_f32 v[10:11], v[10:11], v[72:73]
    v_pk_add_f32 v[8:9], v[8:9], v[52:53]
    v_pk_add_f32 v[10:11], v[10:11], v[74:75]
    v_pk_add_f32 v[8:9], v[8:9], v[54:55]
    v_pk_add_f32 v[10:11], v[10:11], v[76:77]
    v_pk_add_f32 v[8:9], v[8:9], v[56:57]
    v_pk_add_f32 v[10:11], v[10:11], v[78:79]
    v_pk_add_f32 v[8:9], v[8:9], v[58:59]
    v_pk_add_f32 v[10:11], v[10:11], v[80:81]
    v_pk_add_f32 v[8:9], v[8:9], v[60:61]
    v_pk_add_f32 v[10:11], v[10:11], v[82:83]
    v_pk_add_f32 v[8:9], v[8:9], v[62:63]
    v_pk_add_f32 v[10:11], v[10:11], v[84:85]
    v_pk_add_f32 v[8:9], v[8:9], v[64:65]
    v_pk_add_f32 v[10:11], v[10:11], v[86:87]
    v_pk_add_f32 v[8:9], v[8:9], v[66:67]
    v_add_f32 v10, v10, v11
    v_add_f32 v8, v8, v9
    v_rcp_f32 v10, v10
    v_rcp_f32 v8, v8
    v_mul_f32 v10, v10, v5
    v_mul_f32 v8, v8, v5
    v_accvgpr_read_b32 v9, a80
    v_pk_mul_f32 v[48:49], v[48:49], v[8:9] op_sel_hi:[1,0]
    v_pk_mul_f32 v[50:51], v[50:51], v[8:9] op_sel_hi:[1,0]
    v_pk_mul_f32 v[56:57], v[56:57], v[8:9] op_sel_hi:[1,0]
    v_pk_mul_f32 v[58:59], v[58:59], v[8:9] op_sel_hi:[1,0]
    v_cvt_pk_bf16_f32 v48, v48, v49
    v_cvt_pk_bf16_f32 v49, v50, v51
    v_cvt_pk_bf16_f32 v50, v56, v57
    v_cvt_pk_bf16_f32 v51, v58, v59
    ds_write_b128 v9, v[48:51] offset:0
    v_pk_mul_f32 v[64:65], v[64:65], v[8:9] op_sel_hi:[1,0]
    v_pk_mul_f32 v[66:67], v[66:67], v[8:9] op_sel_hi:[1,0]
    v_pk_mul_f32 v[72:73], v[72:73], v[10:11] op_sel_hi:[1,0]
    v_pk_mul_f32 v[74:75], v[74:75], v[10:11] op_sel_hi:[1,0]
    v_cvt_pk_bf16_f32 v64, v64, v65
    v_cvt_pk_bf16_f32 v65, v66, v67
    v_cvt_pk_bf16_f32 v66, v72, v73
    v_cvt_pk_bf16_f32 v67, v74, v75
    ds_write_b128 v9, v[64:67] offset:16
    v_pk_mul_f32 v[52:53], v[52:53], v[8:9] op_sel_hi:[1,0]
    v_pk_mul_f32 v[54:55], v[54:55], v[8:9] op_sel_hi:[1,0]
    v_pk_mul_f32 v[60:61], v[60:61], v[8:9] op_sel_hi:[1,0]
    v_pk_mul_f32 v[62:63], v[62:63], v[8:9] op_sel_hi:[1,0]
    v_cvt_pk_bf16_f32 v52, v52, v53
    v_cvt_pk_bf16_f32 v53, v54, v55
    v_cvt_pk_bf16_f32 v54, v60, v61
    v_cvt_pk_bf16_f32 v55, v62, v63
    ds_write_b128 v9, v[52:55] offset:32
    v_pk_mul_f32 v[68:69], v[68:69], v[10:11] op_sel_hi:[1,0]
    v_pk_mul_f32 v[70:71], v[70:71], v[10:11] op_sel_hi:[1,0]
    v_pk_mul_f32 v[76:77], v[76:77], v[10:11] op_sel_hi:[1,0]
    v_pk_mul_f32 v[78:79], v[78:79], v[10:11] op_sel_hi:[1,0]
    v_cvt_pk_bf16_f32 v68, v68, v69
    v_cvt_pk_bf16_f32 v69, v70, v71
    v_cvt_pk_bf16_f32 v70, v76, v77
    v_cvt_pk_bf16_f32 v71, v78, v79
    ds_write_b128 v9, v[68:71] offset:48
    v_pk_mul_f32 v[80:81], v[80:81], v[10:11] op_sel_hi:[1,0]
    v_pk_mul_f32 v[82:83], v[82:83], v[10:11] op_sel_hi:[1,0]
    v_pk_mul_f32 v[84:85], v[84:85], v[10:11] op_sel_hi:[1,0]
    v_pk_mul_f32 v[86:87], v[86:87], v[10:11] op_sel_hi:[1,0]
    v_cvt_pk_bf16_f32 v80, v80, v81
    v_cvt_pk_bf16_f32 v81, v82, v83
    v_cvt_pk_bf16_f32 v82, v84, v85
    v_cvt_pk_bf16_f32 v83, v86, v87
    ds_write_b128 v9, v[80:83] offset:64
    s_waitcnt lgkmcnt(11)
    v_mfma_f32_32x32x16_bf16 v[16:31], a[16:19], v[240:243], v[16:31]
    ds_read_b128 a[16:19], v2 offset:61440
    v_mfma_f32_32x32x16_bf16 v[16:31], a[20:23], v[244:247], v[16:31]
    ds_read_b128 a[20:23], v2 offset:62464
    buffer_load_dwordx4 a[148:151], v2, s[4:7], s65 offen offset:0 sc1
    s_waitcnt lgkmcnt(11)
    v_mfma_f32_32x32x16_bf16 v[16:31], a[24:27], v[248:251], v[16:31]
    ds_read_b128 a[24:27], v2 offset:63488
    v_mfma_f32_32x32x16_bf16 v[16:31], a[28:31], v[252:255], v[16:31]
    ds_read_b128 a[28:31], v2 offset:64512
    s_add_u32 s64, s67, 81920
    s_add_u32 s65, s64, 4096
    buffer_load_dwordx4 a[152:155], v2, s[4:7], s64 offen offset:0 sc1
    s_waitcnt lgkmcnt(11)
    v_mfma_f32_32x32x16_bf16 v[32:47], a[0:3], v[96:99], 0
    s_waitcnt vmcnt(26)
    s_barrier
    ds_read_b128 a[0:3], v2 offset:0
    s_add_u32 m0, s26, 49152
    s_nop 0
    buffer_load_dwordx4 v3, s[4:7], s20 offen sc1 lds
    s_add_u32 m0, s26, 53248
    v_mfma_f32_32x32x16_bf16 v[32:47], a[4:7], v[100:103], v[32:47]
    ds_read_b128 a[4:7], v2 offset:1024
    buffer_load_dwordx4 v3, s[4:7], s21 offen sc1 lds
    buffer_load_dwordx4 a[156:159], v2, s[4:7], s64 offen offset:1024 sc1
    s_waitcnt lgkmcnt(11)
    v_mfma_f32_32x32x16_bf16 v[32:47], a[8:11], v[104:107], v[32:47]
    ds_read_b128 a[8:11], v2 offset:2048
    v_cvt_pk_bf16_f32 v16, v16, v17
    v_cvt_pk_bf16_f32 v17, v18, v19
    v_cvt_pk_bf16_f32 v18, v20, v21
    v_cvt_pk_bf16_f32 v19, v22, v23
    v_accvgpr_read_b32 v20, a87
    v_mfma_f32_32x32x16_bf16 v[32:47], a[12:15], v[108:111], v[32:47]
    ds_read_b128 a[12:15], v2 offset:3072
    buffer_load_dwordx4 a[160:163], v2, s[4:7], s64 offen offset:2048 sc1
    s_waitcnt lgkmcnt(6)
    v_mfma_f32_32x32x16_bf16 v[32:47], a[16:19], v[112:115], v[32:47]
    ds_read_b128 a[16:19], v2 offset:4096
    ds_write_b64 v0, v[16:17] offset:24
    ds_write_b128 v0, v[18:21] offset:32
    v_cvt_pk_bf16_f32 v92, v24, v25
    v_cvt_pk_bf16_f32 v93, v26, v27
    v_cvt_pk_bf16_f32 v94, v28, v29
    v_cvt_pk_bf16_f32 v95, v30, v31
    v_accvgpr_read_b32 v9, a83
    v_mfma_f32_32x32x16_bf16 v[32:47], a[20:23], v[116:119], v[32:47]
    ds_read_b128 a[20:23], v2 offset:5120
    buffer_load_dwordx4 a[164:167], v2, s[4:7], s64 offen offset:3072 sc1
    v_accvgpr_read_b32 v10, a84
    s_waitcnt lgkmcnt(8)
    v_mfma_f32_32x32x16_bf16 v[32:47], a[24:27], v[120:123], v[32:47]
    ds_read_b128 a[24:27], v2 offset:6144
    v_mfma_f32_32x32x16_bf16 v[32:47], a[28:31], v[124:127], v[32:47]
    ds_read_b128 a[28:31], v2 offset:7168
    buffer_load_dwordx4 a[168:171], v2, s[4:7], s65 offen offset:0 sc1
    s_waitcnt lgkmcnt(8)
    v_mfma_f32_32x32x16_bf16 v[32:47], a[0:3], v[128:131], v[32:47]
    s_waitcnt vmcnt(30)
    s_barrier
    ds_read_b128 a[0:3], v2 offset:8192
    s_add_u32 m0, s26, 57344
    s_nop 0
    buffer_load_dwordx4 v3, s[4:7], s22 offen sc1 lds
    s_add_u32 m0, s26, 61440
    v_mfma_f32_32x32x16_bf16 v[32:47], a[4:7], v[132:135], v[32:47]
    ds_read_b128 a[4:7], v2 offset:9216
    buffer_load_dwordx4 v3, s[4:7], s23 offen sc1 lds
    s_add_u32 s64, s66, 163840
    s_add_u32 s65, s64, 4096
    s_waitcnt lgkmcnt(5)
    v_mfma_f32_32x32x16_bf16 v[32:47], a[8:11], v[136:139], v[32:47]
    ds_read_b128 a[8:11], v2 offset:10240
    buffer_load_dwordx4 a[172:175], v2, s[4:7], s64 offen offset:0 sc1
    v_mfma_f32_32x32x16_bf16 v[32:47], a[12:15], v[140:143], v[32:47]
    ds_read_b128 a[12:15], v2 offset:11264
    s_waitcnt lgkmcnt(6)
    v_mfma_f32_32x32x16_bf16 v[32:47], a[16:19], v[144:147], v[32:47]
    ds_read_b128 a[16:19], v2 offset:12288
    buffer_load_dwordx4 a[176:179], v2, s[4:7], s64 offen offset:1024 sc1
    v_mfma_f32_32x32x16_bf16 v[32:47], a[20:23], v[148:151], v[32:47]
    ds_read_b128 a[20:23], v2 offset:13312
    s_waitcnt lgkmcnt(6)
    v_mfma_f32_32x32x16_bf16 v[32:47], a[24:27], v[152:155], v[32:47]
    ds_read_b128 a[24:27], v2 offset:14336
    buffer_load_dwordx4 a[180:183], v2, s[4:7], s64 offen offset:2048 sc1
    v_mfma_f32_32x32x16_bf16 v[32:47], a[28:31], v[156:159], v[32:47]
    ds_read_b128 a[28:31], v2 offset:15360
    s_waitcnt lgkmcnt(6)
    v_mfma_f32_32x32x16_bf16 v[32:47], a[0:3], v[160:163], v[32:47]
    s_waitcnt vmcnt(33)
    s_barrier
    ds_read_b128 a[0:3], v2 offset:16384
    s_add_u32 m0, s26, 0
    s_nop 0
    buffer_load_dwordx4 v3, s[4:7], s24 offen sc1 lds
    s_add_u32 m0, s26, 4096
    v_mfma_f32_32x32x16_bf16 v[32:47], a[4:7], v[164:167], v[32:47]
    ds_read_b128 a[4:7], v2 offset:17408
    buffer_load_dwordx4 v3, s[4:7], s25 offen sc1 lds
    buffer_load_dwordx4 a[184:187], v2, s[4:7], s64 offen offset:3072 sc1
    ds_read_b64_tr_b16 a[56:57], v10 offset:0
    s_waitcnt lgkmcnt(7)
    v_mfma_f32_32x32x16_bf16 v[32:47], a[8:11], v[168:171], v[32:47]
    ds_read_b128 a[8:11], v2 offset:18432
    ds_read_b64_tr_b16 a[58:59], v10 offset:1600
    ds_read_b64_tr_b16 a[60:61], v9 offset:0
    ds_read_b64_tr_b16 a[62:63], v9 offset:2624
    v_mfma_f32_32x32x16_bf16 v[32:47], a[12:15], v[172:175], v[32:47]
    ds_read_b128 a[12:15], v2 offset:19456
    buffer_load_dwordx4 a[188:191], v2, s[4:7], s65 offen offset:0 sc1
    ds_read_b64_tr_b16 a[64:65], v9 offset:32
    ds_read_b64_tr_b16 a[66:67], v9 offset:2656
    ds_read_b64_tr_b16 a[68:69], v9 offset:64
    ds_read_b64_tr_b16 a[70:71], v9 offset:2688
    s_waitcnt lgkmcnt(14)
    v_mfma_f32_32x32x16_bf16 v[32:47], a[16:19], v[176:179], v[32:47]
    ds_read_b128 a[16:19], v2 offset:20480
    ds_read_b64_tr_b16 a[212:213], v10 offset:3200
    ds_read_b64_tr_b16 a[214:215], v10 offset:4800
    ds_read_b64_tr_b16 a[216:217], v9 offset:5248
    ds_read_b64_tr_b16 a[218:219], v9 offset:7872
    v_mfma_f32_32x32x16_bf16 v[32:47], a[20:23], v[180:183], v[32:47]
    ds_read_b128 a[20:23], v2 offset:21504
    s_add_u32 s64, s67, 163840
    s_add_u32 s65, s64, 4096
    buffer_load_dwordx4 a[192:195], v2, s[4:7], s64 offen offset:0 sc1
    ds_read_b64_tr_b16 a[220:221], v9 offset:5280
    ds_read_b64_tr_b16 a[222:223], v9 offset:7904
    ds_read_b64_tr_b16 a[224:225], v9 offset:5312
    s_waitcnt lgkmcnt(15)
    v_mfma_f32_32x32x16_bf16 v[32:47], a[24:27], v[184:187], v[32:47]
    ds_read_b128 a[24:27], v2 offset:22528
    ds_read_b64_tr_b16 a[226:227], v9 offset:7936
    v_mfma_f32_32x32x16_bf16 v[32:47], a[28:31], v[188:191], v[32:47]
    ds_read_b128 a[28:31], v2 offset:23552
    buffer_load_dwordx4 a[196:199], v2, s[4:7], s64 offen offset:1024 sc1
    ds_read_b64_tr_b16 a[228:229], v10 offset:6400
    ds_read_b64_tr_b16 a[230:231], v10 offset:8000
    ds_read_b64_tr_b16 a[232:233], v9 offset:10496
    ds_read_b64_tr_b16 a[234:235], v9 offset:13120
    s_waitcnt lgkmcnt(15)
    v_mfma_f32_32x32x16_bf16 v[32:47], a[0:3], v[192:195], v[32:47]
    s_waitcnt vmcnt(33)
    s_barrier
    ds_read_b128 a[0:3], v2 offset:24576
    s_add_u32 m0, s26, 8192
    v_add_u32 v3, 4294885376, v3
    buffer_load_dwordx4 v3, s[4:7], s16 offen sc1 lds
    s_add_u32 m0, s26, 12288
    v_mfma_f32_32x32x16_bf16 v[32:47], a[4:7], v[196:199], v[32:47]
    ds_read_b128 a[4:7], v2 offset:25600
    buffer_load_dwordx4 v3, s[4:7], s17 offen sc1 lds
    buffer_load_dwordx4 a[200:203], v2, s[4:7], s64 offen offset:2048 sc1
    ds_read_b64_tr_b16 a[236:237], v9 offset:10528
    s_waitcnt lgkmcnt(15)
    v_mfma_f32_32x32x16_bf16 v[32:47], a[8:11], v[200:203], v[32:47]
    ds_read_b128 a[8:11], v2 offset:26624
    ds_read_b64_tr_b16 a[238:239], v9 offset:13152
    ds_read_b64_tr_b16 a[240:241], v9 offset:10560
    ds_read_b64_tr_b16 a[242:243], v9 offset:13184
    v_mfma_f32_32x32x16_bf16 v[32:47], a[12:15], v[204:207], v[32:47]
    ds_read_b128 a[12:15], v2 offset:27648
    buffer_load_dwordx4 a[204:207], v2, s[4:7], s64 offen offset:3072 sc1
    ds_read_b64_tr_b16 v[48:49], v10 offset:9600
    ds_read_b64_tr_b16 v[50:51], v10 offset:11200
    ds_read_b64_tr_b16 v[52:53], v9 offset:15744
    ds_read_b64_tr_b16 v[54:55], v9 offset:18368
    s_waitcnt lgkmcnt(15)
    v_mfma_f32_32x32x16_bf16 v[32:47], a[16:19], v[208:211], v[32:47]
    ds_read_b128 a[16:19], v2 offset:28672
    ds_read_b64_tr_b16 v[56:57], v9 offset:15776
    ds_read_b64_tr_b16 v[58:59], v9 offset:18400
    ds_read_b64_tr_b16 v[60:61], v9 offset:15808
    ds_read_b64_tr_b16 v[62:63], v9 offset:18432
    v_mfma_f32_32x32x16_bf16 v[32:47], a[20:23], v[212:215], v[32:47]
    ds_read_b128 a[20:23], v2 offset:29696
    buffer_load_dwordx4 a[208:211], v2, s[4:7], s65 offen offset:0 sc1
    s_waitcnt lgkmcnt(15)
    v_mfma_f32_32x32x16_bf16 v[32:47], a[24:27], v[216:219], v[32:47]
    ds_read_b128 a[24:27], v2 offset:30720
    v_mfma_f32_16x16x32_bf16 v[68:71], a[60:63], a[56:59], 0
    v_mfma_f32_16x16x32_bf16 v[72:75], a[64:67], a[56:59], 0
    v_mfma_f32_16x16x32_bf16 v[76:79], a[68:71], a[56:59], 0
    v_mfma_f32_32x32x16_bf16 v[32:47], a[28:31], v[220:223], v[32:47]
    ds_read_b128 a[28:31], v2 offset:31744
    v_mfma_f32_16x16x32_bf16 v[68:71], a[216:219], a[212:215], v[68:71]
    v_mfma_f32_16x16x32_bf16 v[72:75], a[220:223], a[212:215], v[72:75]
    v_mfma_f32_16x16x32_bf16 v[76:79], a[224:227], a[212:215], v[76:79]
    s_waitcnt lgkmcnt(15)
    v_mfma_f32_32x32x16_bf16 v[32:47], a[0:3], v[224:227], v[32:47]
    s_waitcnt vmcnt(32)
    s_barrier
    ds_read_b128 a[0:3], v2 offset:32768
    s_add_u32 m0, s26, 16384
    s_nop 0
    buffer_load_dwordx4 v3, s[4:7], s18 offen sc1 lds
    s_add_u32 m0, s26, 20480
    v_mfma_f32_32x32x16_bf16 v[32:47], a[4:7], v[228:231], v[32:47]
    ds_read_b128 a[4:7], v2 offset:33792
    buffer_load_dwordx4 v3, s[4:7], s19 offen sc1 lds
    s_waitcnt lgkmcnt(14)
    v_mfma_f32_16x16x32_bf16 v[68:71], a[232:235], a[228:231], v[68:71]
    v_mfma_f32_16x16x32_bf16 v[72:75], a[236:239], a[228:231], v[72:75]
    v_mfma_f32_16x16x32_bf16 v[76:79], a[240:243], a[228:231], v[76:79]
    v_mfma_f32_32x32x16_bf16 v[32:47], a[8:11], v[232:235], v[32:47]
    ds_read_b128 a[8:11], v2 offset:34816
    s_waitcnt lgkmcnt(5)
    v_mfma_f32_16x16x32_bf16 v[68:71], v[52:55], v[48:51], v[68:71]
    v_mfma_f32_16x16x32_bf16 v[72:75], v[56:59], v[48:51], v[72:75]
    v_mfma_f32_16x16x32_bf16 v[76:79], v[60:63], v[48:51], v[76:79]
    v_mfma_f32_32x32x16_bf16 v[32:47], a[12:15], v[236:239], v[32:47]
    ds_read_b128 a[12:15], v2 offset:35840
    v_mfma_f32_32x32x16_bf16 v[32:47], a[16:19], v[240:243], v[32:47]
    ds_read_b128 a[16:19], v2 offset:36864
    v_accvgpr_read_b32 v8, a86
    s_nop 0
    v_cvt_pk_bf16_f32 v80, v68, v69
    v_cvt_pk_bf16_f32 v81, v70, v71
    v_cvt_pk_bf16_f32 v82, v72, v73
    v_cvt_pk_bf16_f32 v83, v74, v75
    v_cvt_pk_bf16_f32 v84, v76, v77
    v_cvt_pk_bf16_f32 v85, v78, v79
    v_mfma_f32_32x32x16_bf16 v[32:47], a[20:23], v[244:247], v[32:47]
    ds_read_b128 a[20:23], v2 offset:37888
    buffer_store_dwordx4 v[80:83], v8, s[4:7], s31 offen sc1
    buffer_store_dwordx2 v[84:85], v7, s[4:7], s31 offen sc1
    v_lshrrev_b32 v72, 9, v2
    s_waitcnt lgkmcnt(6)
    v_mfma_f32_32x32x16_bf16 v[32:47], a[24:27], v[248:251], v[32:47]
    ds_read_b128 a[24:27], v2 offset:38912
    v_lshlrev_b32 v72, 6, v72
    v_add_u32 v72, 160768, v72
    ds_read_b128 v[64:67], v72 offset:0
    ds_read_b128 v[68:71], v72 offset:16
    v_mfma_f32_32x32x16_bf16 v[32:47], a[28:31], v[252:255], v[32:47]
    ds_read_b128 a[28:31], v2 offset:39936
    s_waitcnt lgkmcnt(8)
    v_mfma_f32_32x32x16_bf16 v[16:31], a[0:3], v[96:99], 0
    s_waitcnt vmcnt(30)
    s_barrier
    ds_read_b128 a[0:3], v2 offset:40960
    s_add_u32 m0, s26, 24576
    v_mfma_f32_32x32x16_bf16 v[16:31], a[4:7], v[100:103], v[16:31]
    ds_read_b128 a[4:7], v2 offset:41984
    buffer_load_dwordx4 v3, s[4:7], s20 offen sc1 lds
    s_add_u32 m0, s26, 28672
    s_waitcnt lgkmcnt(8)
    v_mfma_f32_32x32x16_bf16 v[16:31], a[8:11], v[104:107], v[16:31]
    ds_read_b128 a[8:11], v2 offset:43008
    buffer_load_dwordx4 v3, s[4:7], s21 offen sc1 lds
    s_waitcnt lgkmcnt(5)
    v_fma_f32 v32, v32, v5, v64
    v_mfma_f32_32x32x16_bf16 v[16:31], a[12:15], v[108:111], v[16:31]
    ds_read_b128 a[12:15], v2 offset:44032
    v_fma_f32 v33, v33, v5, v65
    v_fma_f32 v34, v34, v5, v66
    v_fma_f32 v35, v35, v5, v67
    ds_read_b128 v[64:67], v72 offset:32
    v_max_f32 v32, 0, v32
    v_max_f32 v33, 0, v33
    v_max_f32 v34, 0, v34
    v_mfma_f32_32x32x16_bf16 v[16:31], a[16:19], v[112:115], v[16:31]
    ds_read_b128 a[16:19], v2 offset:45056
    v_max_f32 v35, 0, v35
    v_mul_f32 v32, v32, v32
    v_mul_f32 v33, v33, v33
    v_mul_f32 v34, v34, v34
    v_mul_f32 v35, v35, v35
    v_cvt_pk_bf16_f32 v76, v32, v33
    v_cvt_pk_bf16_f32 v77, v34, v35
    v_mfma_f32_32x32x16_bf16 v[16:31], a[20:23], v[116:119], v[16:31]
    ds_read_b128 a[20:23], v2 offset:46080
    s_waitcnt lgkmcnt(8)
    v_fma_f32 v36, v36, v5, v68
    v_fma_f32 v37, v37, v5, v69
    v_fma_f32 v38, v38, v5, v70
    v_fma_f32 v39, v39, v5, v71
    ds_read_b128 v[68:71], v72 offset:48
    v_max_f32 v36, 0, v36
    s_waitcnt lgkmcnt(8)
    v_mfma_f32_32x32x16_bf16 v[16:31], a[24:27], v[120:123], v[16:31]
    ds_read_b128 a[24:27], v2 offset:47104
    v_max_f32 v37, 0, v37
    v_max_f32 v38, 0, v38
    v_max_f32 v39, 0, v39
    v_mul_f32 v36, v36, v36
    v_mul_f32 v37, v37, v37
    v_mul_f32 v38, v38, v38
    v_mfma_f32_32x32x16_bf16 v[16:31], a[28:31], v[124:127], v[16:31]
    ds_read_b128 a[28:31], v2 offset:48128
    v_mul_f32 v39, v39, v39
    v_cvt_pk_bf16_f32 v78, v36, v37
    v_cvt_pk_bf16_f32 v79, v38, v39
    s_waitcnt lgkmcnt(5)
    v_fma_f32 v40, v40, v5, v64
    v_fma_f32 v41, v41, v5, v65
    v_fma_f32 v42, v42, v5, v66
    v_mfma_f32_32x32x16_bf16 v[16:31], a[0:3], v[128:131], v[16:31]
    s_waitcnt vmcnt(26)
    s_barrier
    ds_read_b128 a[0:3], v2 offset:49152
    s_add_u32 m0, s26, 32768
    s_nop 0
    buffer_load_dwordx4 v3, s[4:7], s22 offen sc1 lds
    v_mfma_f32_32x32x16_bf16 v[16:31], a[4:7], v[132:135], v[16:31]
    ds_read_b128 a[4:7], v2 offset:50176
    s_add_u32 m0, s26, 36864
    s_nop 0
    buffer_load_dwordx4 v3, s[4:7], s23 offen sc1 lds
    v_fma_f32 v43, v43, v5, v67
    v_max_f32 v40, 0, v40
    v_mfma_f32_32x32x16_bf16 v[16:31], a[8:11], v[136:139], v[16:31]
    ds_read_b128 a[8:11], v2 offset:51200
    v_max_f32 v41, 0, v41
    v_max_f32 v42, 0, v42
    v_max_f32 v43, 0, v43
    v_mul_f32 v40, v40, v40
    v_mul_f32 v41, v41, v41
    v_mul_f32 v42, v42, v42
    v_mul_f32 v43, v43, v43
    v_mfma_f32_32x32x16_bf16 v[16:31], a[12:15], v[140:143], v[16:31]
    ds_read_b128 a[12:15], v2 offset:52224
    v_cvt_pk_bf16_f32 v80, v40, v41
    v_cvt_pk_bf16_f32 v81, v42, v43
    s_waitcnt lgkmcnt(6)
    v_fma_f32 v44, v44, v5, v68
    v_fma_f32 v45, v45, v5, v69
    v_fma_f32 v46, v46, v5, v70
    v_fma_f32 v47, v47, v5, v71
    v_mfma_f32_32x32x16_bf16 v[16:31], a[16:19], v[144:147], v[16:31]
    ds_read_b128 a[16:19], v2 offset:53248
    v_max_f32 v44, 0, v44
    v_max_f32 v45, 0, v45
    v_max_f32 v46, 0, v46
    v_max_f32 v47, 0, v47
    v_mul_f32 v44, v44, v44
    v_mul_f32 v45, v45, v45
    v_mul_f32 v46, v46, v46
    v_mfma_f32_32x32x16_bf16 v[16:31], a[20:23], v[148:151], v[16:31]
    ds_read_b128 a[20:23], v2 offset:54272
    v_mul_f32 v47, v47, v47
    v_cvt_pk_bf16_f32 v82, v44, v45
    v_cvt_pk_bf16_f32 v83, v46, v47
    s_waitcnt lgkmcnt(6)
    v_mfma_f32_32x32x16_bf16 v[16:31], a[24:27], v[152:155], v[16:31]
    ds_read_b128 a[24:27], v2 offset:55296
    v_mfma_f32_32x32x16_bf16 v[16:31], a[28:31], v[156:159], v[16:31]
    ds_read_b128 a[28:31], v2 offset:56320
    s_waitcnt lgkmcnt(6)
    v_mfma_f32_32x32x16_bf16 v[16:31], a[0:3], v[160:163], v[16:31]
    s_waitcnt vmcnt(22)
    s_barrier
    ds_read_b128 a[0:3], v2 offset:57344
    s_add_u32 m0, s26, 40960
    v_mfma_f32_32x32x16_bf16 v[16:31], a[4:7], v[164:167], v[16:31]
    ds_read_b128 a[4:7], v2 offset:58368
    buffer_load_dwordx4 v3, s[4:7], s24 offen sc1 lds
    s_add_u32 m0, s26, 45056
    s_waitcnt lgkmcnt(6)
    v_mfma_f32_32x32x16_bf16 v[16:31], a[8:11], v[168:171], v[16:31]
    ds_read_b128 a[8:11], v2 offset:59392
    buffer_load_dwordx4 v3, s[4:7], s25 offen sc1 lds
    v_mfma_f32_32x32x16_bf16 v[16:31], a[12:15], v[172:175], v[16:31]
    ds_read_b128 a[12:15], v2 offset:60416
    s_waitcnt lgkmcnt(6)
    v_mfma_f32_32x32x16_bf16 v[16:31], a[16:19], v[176:179], v[16:31]
    ds_read_b128 a[16:19], v2 offset:61440
    v_mfma_f32_32x32x16_bf16 v[16:31], a[20:23], v[180:183], v[16:31]
    ds_read_b128 a[20:23], v2 offset:62464
    s_waitcnt lgkmcnt(6)
    v_mfma_f32_32x32x16_bf16 v[16:31], a[24:27], v[184:187], v[16:31]
    ds_read_b128 a[24:27], v2 offset:63488
    s_waitcnt vmcnt(6)
    s_bfm_b64 exec, 8, 0
    buffer_store_dwordx4 a[252:255], v2, s[4:7], s33 offen sc1
    s_mov_b64 exec, -1
    v_mfma_f32_32x32x16_bf16 v[16:31], a[28:31], v[188:191], v[16:31]
    ds_read_b128 a[28:31], v2 offset:64512
    v_accvgpr_read_b32 v7, a254
    s_nop 0
    v_lshrrev_b32 v7, 20, v7
    s_lshl_b32 s35, s53, 16
    s_lshl_b32 s36, s54, 14
    s_add_u32 s35, s35, s36
    s_add_u32 s35, s35, 16842752
    s_waitcnt lgkmcnt(6)
    v_mfma_f32_32x32x16_bf16 v[16:31], a[0:3], v[192:195], v[16:31]
    s_barrier
    ds_read_b128 a[0:3], v2 offset:0
    s_add_u32 m0, s26, 49152
    v_add_u32 v3, 122880, v3
    buffer_load_dwordx4 v3, s[4:7], s16 offen sc1 lds
    v_mfma_f32_32x32x16_bf16 v[16:31], a[4:7], v[196:199], v[16:31]
    ds_read_b128 a[4:7], v2 offset:1024
    s_add_u32 m0, s26, 53248
    s_nop 0
    buffer_load_dwordx4 v3, s[4:7], s17 offen sc1 lds
    s_waitcnt lgkmcnt(6)
    v_mfma_f32_32x32x16_bf16 v[16:31], a[8:11], v[200:203], v[16:31]
    ds_read_b128 a[8:11], v2 offset:2048
    buffer_store_dwordx4 v[76:79], v6, s[4:7], s30 offen offset:0 sc1
    v_mfma_f32_32x32x16_bf16 v[16:31], a[12:15], v[204:207], v[16:31]
    ds_read_b128 a[12:15], v2 offset:3072
    buffer_store_dwordx4 v[80:83], v6, s[4:7], s30 offen offset:256 sc1
    s_add_u32 s30, s30, 65536
    ds_read_b128 v[64:67], v72 offset:128
    ds_read_b128 v[68:71], v72 offset:144
    s_waitcnt lgkmcnt(8)
    v_mfma_f32_32x32x16_bf16 v[16:31], a[16:19], v[208:211], v[16:31]
    ds_read_b128 a[16:19], v2 offset:4096
    v_mfma_f32_32x32x16_bf16 v[16:31], a[20:23], v[212:215], v[16:31]
    ds_read_b128 a[20:23], v2 offset:5120
    s_waitcnt lgkmcnt(8)
    v_mfma_f32_32x32x16_bf16 v[16:31], a[24:27], v[216:219], v[16:31]
    ds_read_b128 a[24:27], v2 offset:6144
    v_mfma_f32_32x32x16_bf16 v[16:31], a[28:31], v[220:223], v[16:31]
    ds_read_b128 a[28:31], v2 offset:7168
    s_waitcnt lgkmcnt(8)
    v_mfma_f32_32x32x16_bf16 v[16:31], a[0:3], v[224:227], v[16:31]
    s_barrier
    ds_read_b128 a[0:3], v2 offset:8192
    s_add_u32 m0, s26, 57344
    s_nop 0
    buffer_load_dwordx4 v3, s[4:7], s18 offen sc1 lds
    v_mfma_f32_32x32x16_bf16 v[16:31], a[4:7], v[228:231], v[16:31]
    ds_read_b128 a[4:7], v2 offset:9216
    s_add_u32 m0, s26, 61440
    s_nop 0
    buffer_load_dwordx4 v3, s[4:7], s19 offen sc1 lds
    s_waitcnt lgkmcnt(8)
    v_mfma_f32_32x32x16_bf16 v[16:31], a[8:11], v[232:235], v[16:31]
    ds_read_b128 a[8:11], v2 offset:10240
    v_mfma_f32_32x32x16_bf16 v[16:31], a[12:15], v[236:239], v[16:31]
    ds_read_b128 a[12:15], v2 offset:11264
    s_waitcnt lgkmcnt(6)
    v_mfma_f32_32x32x16_bf16 v[16:31], a[16:19], v[240:243], v[16:31]
    ds_read_b128 a[16:19], v2 offset:12288
    v_mfma_f32_32x32x16_bf16 v[16:31], a[20:23], v[244:247], v[16:31]
    ds_read_b128 a[20:23], v2 offset:13312
    s_waitcnt lgkmcnt(6)
    v_mfma_f32_32x32x16_bf16 v[16:31], a[24:27], v[248:251], v[16:31]
    ds_read_b128 a[24:27], v2 offset:14336
    v_mfma_f32_32x32x16_bf16 v[16:31], a[28:31], v[252:255], v[16:31]
    ds_read_b128 a[28:31], v2 offset:15360
    s_waitcnt lgkmcnt(6)
    v_mfma_f32_32x32x16_bf16 v[32:47], a[0:3], v[96:99], 0
    s_barrier
    ds_read_b128 a[0:3], v2 offset:16384
    s_add_u32 m0, s26, 0
    s_nop 0
    buffer_load_dwordx4 v3, s[4:7], s20 offen sc1 lds
    v_mfma_f32_32x32x16_bf16 v[32:47], a[4:7], v[100:103], v[32:47]
    ds_read_b128 a[4:7], v2 offset:17408
    s_add_u32 m0, s26, 4096
    s_nop 0
    buffer_load_dwordx4 v3, s[4:7], s21 offen sc1 lds
    s_waitcnt lgkmcnt(6)
    v_mfma_f32_32x32x16_bf16 v[32:47], a[8:11], v[104:107], v[32:47]
    ds_read_b128 a[8:11], v2 offset:18432
    v_fma_f32 v16, v16, v5, v64
    v_fma_f32 v17, v17, v5, v65
    v_fma_f32 v18, v18, v5, v66
    v_fma_f32 v19, v19, v5, v67
    ds_read_b128 v[64:67], v72 offset:160
    v_mfma_f32_32x32x16_bf16 v[32:47], a[12:15], v[108:111], v[32:47]
    ds_read_b128 a[12:15], v2 offset:19456
    v_max_f32 v16, 0, v16
    v_max_f32 v17, 0, v17
    v_max_f32 v18, 0, v18
    v_max_f32 v19, 0, v19
    v_mul_f32 v16, v16, v16
    v_mul_f32 v17, v17, v17
    v_mul_f32 v18, v18, v18
    s_waitcnt lgkmcnt(7)
    v_mfma_f32_32x32x16_bf16 v[32:47], a[16:19], v[112:115], v[32:47]
    ds_read_b128 a[16:19], v2 offset:20480
    v_mul_f32 v19, v19, v19
    v_cvt_pk_bf16_f32 v48, v16, v17
    v_cvt_pk_bf16_f32 v49, v18, v19
    v_fma_f32 v20, v20, v5, v68
    v_fma_f32 v21, v21, v5, v69
    v_mfma_f32_32x32x16_bf16 v[32:47], a[20:23], v[116:119], v[32:47]
    ds_read_b128 a[20:23], v2 offset:21504
    v_fma_f32 v22, v22, v5, v70
    v_fma_f32 v23, v23, v5, v71
    ds_read_b128 v[68:71], v72 offset:176
    v_max_f32 v20, 0, v20
    v_max_f32 v21, 0, v21
    v_max_f32 v22, 0, v22
    v_max_f32 v23, 0, v23
    s_waitcnt lgkmcnt(8)
    v_mfma_f32_32x32x16_bf16 v[32:47], a[24:27], v[120:123], v[32:47]
    ds_read_b128 a[24:27], v2 offset:22528
    v_mul_f32 v20, v20, v20
    v_mul_f32 v21, v21, v21
    v_mul_f32 v22, v22, v22
    v_mul_f32 v23, v23, v23
    v_cvt_pk_bf16_f32 v50, v20, v21
    v_cvt_pk_bf16_f32 v51, v22, v23
    v_mfma_f32_32x32x16_bf16 v[32:47], a[28:31], v[124:127], v[32:47]
    ds_read_b128 a[28:31], v2 offset:23552
    s_waitcnt lgkmcnt(6)
    v_fma_f32 v24, v24, v5, v64
    v_fma_f32 v25, v25, v5, v65
    v_fma_f32 v26, v26, v5, v66
    v_fma_f32 v27, v27, v5, v67
    v_max_f32 v24, 0, v24
    v_max_f32 v25, 0, v25
    v_mfma_f32_32x32x16_bf16 v[32:47], a[0:3], v[128:131], v[32:47]
    s_waitcnt vmcnt(13)
    s_barrier
    ds_read_b128 a[0:3], v2 offset:24576
    s_add_u32 m0, s26, 8192
    s_nop 0
    buffer_load_dwordx4 v3, s[4:7], s22 offen sc1 lds
    v_mfma_f32_32x32x16_bf16 v[32:47], a[4:7], v[132:135], v[32:47]
    ds_read_b128 a[4:7], v2 offset:25600
    s_add_u32 m0, s26, 12288
    s_nop 0
    buffer_load_dwordx4 v3, s[4:7], s23 offen sc1 lds
    v_max_f32 v26, 0, v26
    v_max_f32 v27, 0, v27
    s_waitcnt lgkmcnt(7)
    v_mfma_f32_32x32x16_bf16 v[32:47], a[8:11], v[136:139], v[32:47]
    ds_read_b128 a[8:11], v2 offset:26624
    v_mul_f32 v24, v24, v24
    v_mul_f32 v25, v25, v25
    v_mul_f32 v26, v26, v26
    v_mul_f32 v27, v27, v27
    v_cvt_pk_bf16_f32 v52, v24, v25
    v_cvt_pk_bf16_f32 v53, v26, v27
    v_mfma_f32_32x32x16_bf16 v[32:47], a[12:15], v[140:143], v[32:47]
    ds_read_b128 a[12:15], v2 offset:27648
    s_waitcnt lgkmcnt(6)
    v_fma_f32 v28, v28, v5, v68
    v_fma_f32 v29, v29, v5, v69
    v_fma_f32 v30, v30, v5, v70
    v_fma_f32 v31, v31, v5, v71
    v_max_f32 v28, 0, v28
    v_max_f32 v29, 0, v29
    v_mfma_f32_32x32x16_bf16 v[32:47], a[16:19], v[144:147], v[32:47]
    ds_read_b128 a[16:19], v2 offset:28672
    v_max_f32 v30, 0, v30
    v_max_f32 v31, 0, v31
    v_mul_f32 v28, v28, v28
    v_mul_f32 v29, v29, v29
    v_mul_f32 v30, v30, v30
    v_mul_f32 v31, v31, v31
    v_cvt_pk_bf16_f32 v54, v28, v29
    v_mfma_f32_32x32x16_bf16 v[32:47], a[20:23], v[148:151], v[32:47]
    ds_read_b128 a[20:23], v2 offset:29696
    v_min_u32 v0, 496, v2
    v_lshlrev_b32 v0, 3, v0
    buffer_load_dwordx2 v[0:1], v0, s[4:7], s39 offen offset:0 sc1
    v_cvt_pk_bf16_f32 v55, v30, v31
    s_waitcnt lgkmcnt(6)
    v_mfma_f32_32x32x16_bf16 v[32:47], a[24:27], v[152:155], v[32:47]
    ds_read_b128 a[24:27], v2 offset:30720
    v_mfma_f32_32x32x16_bf16 v[32:47], a[28:31], v[156:159], v[32:47]
    ds_read_b128 a[28:31], v2 offset:31744
    s_waitcnt lgkmcnt(6)
    v_mfma_f32_32x32x16_bf16 v[32:47], a[0:3], v[160:163], v[32:47]
    s_waitcnt vmcnt(14)
    s_barrier
    ds_read_b128 a[0:3], v2 offset:32768
    s_add_u32 m0, s26, 16384
    v_mfma_f32_32x32x16_bf16 v[32:47], a[4:7], v[164:167], v[32:47]
    ds_read_b128 a[4:7], v2 offset:33792
    buffer_load_dwordx4 v3, s[4:7], s24 offen sc1 lds
    s_add_u32 m0, s26, 20480
    s_waitcnt lgkmcnt(6)
    v_mfma_f32_32x32x16_bf16 v[32:47], a[8:11], v[168:171], v[32:47]
    ds_read_b128 a[8:11], v2 offset:34816
    buffer_load_dwordx4 v3, s[4:7], s25 offen sc1 lds
    v_mfma_f32_32x32x16_bf16 v[32:47], a[12:15], v[172:175], v[32:47]
    ds_read_b128 a[12:15], v2 offset:35840
    s_waitcnt lgkmcnt(6)
    v_mfma_f32_32x32x16_bf16 v[32:47], a[16:19], v[176:179], v[32:47]
    ds_read_b128 a[16:19], v2 offset:36864
    v_mfma_f32_32x32x16_bf16 v[32:47], a[20:23], v[180:183], v[32:47]
    ds_read_b128 a[20:23], v2 offset:37888
    s_waitcnt lgkmcnt(6)
    v_mfma_f32_32x32x16_bf16 v[32:47], a[24:27], v[184:187], v[32:47]
    ds_read_b128 a[24:27], v2 offset:38912
    v_mfma_f32_32x32x16_bf16 v[32:47], a[28:31], v[188:191], v[32:47]
    ds_read_b128 a[28:31], v2 offset:39936
    s_waitcnt lgkmcnt(6)
    v_mfma_f32_32x32x16_bf16 v[32:47], a[0:3], v[192:195], v[32:47]
    s_waitcnt vmcnt(14)
    s_barrier
    ds_read_b128 a[0:3], v2 offset:40960
    v_mfma_f32_32x32x16_bf16 v[32:47], a[4:7], v[196:199], v[32:47]
    ds_read_b128 a[4:7], v2 offset:41984
    s_waitcnt lgkmcnt(6)
    v_mfma_f32_32x32x16_bf16 v[32:47], a[8:11], v[200:203], v[32:47]
    ds_read_b128 a[8:11], v2 offset:43008
    v_mfma_f32_32x32x16_bf16 v[32:47], a[12:15], v[204:207], v[32:47]
    ds_read_b128 a[12:15], v2 offset:44032
    s_waitcnt lgkmcnt(6)
    v_mfma_f32_32x32x16_bf16 v[32:47], a[16:19], v[208:211], v[32:47]
    ds_read_b128 a[16:19], v2 offset:45056
    v_mfma_f32_32x32x16_bf16 v[32:47], a[20:23], v[212:215], v[32:47]
    ds_read_b128 a[20:23], v2 offset:46080
    s_waitcnt lgkmcnt(6)
    v_mfma_f32_32x32x16_bf16 v[32:47], a[24:27], v[216:219], v[32:47]
    ds_read_b128 a[24:27], v2 offset:47104
    v_mfma_f32_32x32x16_bf16 v[32:47], a[28:31], v[220:223], v[32:47]
    ds_read_b128 a[28:31], v2 offset:48128
    s_waitcnt vmcnt(2)
    v_cmp_ne_u64 vcc, s[58:59], v[0:1]
    s_nop 0
    s_cbranch_vccnz L_p5_retry
L_p5_ok:
    s_waitcnt lgkmcnt(6)
    v_mfma_f32_32x32x16_bf16 v[32:47], a[0:3], v[224:227], v[32:47]
    s_barrier
    ds_read_b128 a[0:3], v2 offset:49152
    s_bfm_b64 exec, 8, 0
    buffer_store_dwordx4 a[252:255], v2, s[4:7], s32 offen sc1
    s_mov_b64 exec, -1
    s_add_u32 s32, s32, 2048
    v_mfma_f32_32x32x16_bf16 v[32:47], a[4:7], v[228:231], v[32:47]
    ds_read_b128 a[4:7], v2 offset:50176
    buffer_load_dwordx4 a[56:59], v7, s[4:7], s35 offen offset:0 sc1
    s_waitcnt lgkmcnt(6)
    v_mfma_f32_32x32x16_bf16 v[32:47], a[8:11], v[232:235], v[32:47]
    ds_read_b128 a[8:11], v2 offset:51200
    buffer_load_dwordx4 a[60:63], v7, s[4:7], s35 offen offset:1024 sc1
    v_mfma_f32_32x32x16_bf16 v[32:47], a[12:15], v[236:239], v[32:47]
    ds_read_b128 a[12:15], v2 offset:52224
    buffer_load_dwordx4 a[64:67], v7, s[4:7], s35 offen offset:2048 sc1
    s_waitcnt lgkmcnt(6)
    v_mfma_f32_32x32x16_bf16 v[32:47], a[16:19], v[240:243], v[32:47]
    ds_read_b128 a[16:19], v2 offset:53248
    buffer_load_dwordx4 a[68:71], v7, s[4:7], s35 offen offset:3072 sc1
    s_add_u32 s35, s35, 4096
    v_mfma_f32_32x32x16_bf16 v[32:47], a[20:23], v[244:247], v[32:47]
    ds_read_b128 a[20:23], v2 offset:54272
    buffer_load_dwordx4 a[72:75], v7, s[4:7], s35 offen offset:0 sc1
    s_waitcnt lgkmcnt(6)
    v_mfma_f32_32x32x16_bf16 v[32:47], a[24:27], v[248:251], v[32:47]
    ds_read_b128 a[24:27], v2 offset:55296
    buffer_load_dwordx4 a[76:79], v7, s[4:7], s35 offen offset:1024 sc1
    v_mfma_f32_32x32x16_bf16 v[32:47], a[28:31], v[252:255], v[32:47]
    ds_read_b128 a[28:31], v2 offset:56320
    buffer_load_dwordx4 a[80:83], v7, s[4:7], s35 offen offset:2048 sc1
    s_waitcnt lgkmcnt(6)
    v_mfma_f32_32x32x16_bf16 v[16:31], a[0:3], v[96:99], 0
    s_barrier
    ds_read_b128 a[0:3], v2 offset:57344
    buffer_load_dwordx4 a[84:87], v7, s[4:7], s35 offen offset:3072 sc1
    s_add_u32 s35, s35, 4096
    v_mfma_f32_32x32x16_bf16 v[16:31], a[4:7], v[100:103], v[16:31]
    ds_read_b128 a[4:7], v2 offset:58368
    buffer_load_dwordx4 a[212:215], v7, s[4:7], s35 offen offset:0 sc1
    s_waitcnt lgkmcnt(6)
    v_mfma_f32_32x32x16_bf16 v[16:31], a[8:11], v[104:107], v[16:31]
    ds_read_b128 a[8:11], v2 offset:59392
    buffer_load_dwordx4 a[216:219], v7, s[4:7], s35 offen offset:1024 sc1
    v_mfma_f32_32x32x16_bf16 v[16:31], a[12:15], v[108:111], v[16:31]
    ds_read_b128 a[12:15], v2 offset:60416
    buffer_load_dwordx4 a[220:223], v7, s[4:7], s35 offen offset:2048 sc1
    s_waitcnt lgkmcnt(6)
    v_mfma_f32_32x32x16_bf16 v[16:31], a[16:19], v[112:115], v[16:31]
    ds_read_b128 a[16:19], v2 offset:61440
    buffer_load_dwordx4 a[224:227], v7, s[4:7], s35 offen offset:3072 sc1
    s_add_u32 s35, s35, 4096
    v_mfma_f32_32x32x16_bf16 v[16:31], a[20:23], v[116:119], v[16:31]
    ds_read_b128 a[20:23], v2 offset:62464
    buffer_load_dwordx4 a[228:231], v7, s[4:7], s35 offen offset:0 sc1
    s_waitcnt lgkmcnt(6)
    v_mfma_f32_32x32x16_bf16 v[16:31], a[24:27], v[120:123], v[16:31]
    ds_read_b128 a[24:27], v2 offset:63488
    buffer_load_dwordx4 a[232:235], v7, s[4:7], s35 offen offset:1024 sc1
    v_mfma_f32_32x32x16_bf16 v[16:31], a[28:31], v[124:127], v[16:31]
    ds_read_b128 a[28:31], v2 offset:64512
    buffer_load_dwordx4 a[236:239], v7, s[4:7], s35 offen offset:2048 sc1
    s_waitcnt lgkmcnt(6)
    v_mfma_f32_32x32x16_bf16 v[16:31], a[0:3], v[128:131], v[16:31]
    s_barrier
    ds_read_b128 a[0:3], v2 offset:0
    buffer_load_dwordx4 a[240:243], v7, s[4:7], s35 offen offset:3072 sc1
    v_mfma_f32_32x32x16_bf16 v[16:31], a[4:7], v[132:135], v[16:31]
    ds_read_b128 a[4:7], v2 offset:1024
    buffer_store_dwordx4 v[48:51], v6, s[4:7], s30 offen offset:0 sc1
    buffer_store_dwordx4 v[52:55], v6, s[4:7], s30 offen offset:256 sc1
    s_add_u32 s30, s30, 65536
    s_waitcnt lgkmcnt(6)
    v_mfma_f32_32x32x16_bf16 v[16:31], a[8:11], v[136:139], v[16:31]
    ds_read_b128 a[8:11], v2 offset:2048
    v_cvt_pk_bf16_f32 v88, v32, v33
    v_cvt_pk_bf16_f32 v89, v34, v35
    v_cvt_pk_bf16_f32 v90, v36, v37
    v_cvt_pk_bf16_f32 v91, v38, v39
    v_cvt_pk_bf16_f32 v12, v40, v41
    v_cvt_pk_bf16_f32 v13, v42, v43
    v_mfma_f32_32x32x16_bf16 v[48:63], a[32:35], v[92:95], 0
    v_mfma_f32_32x32x16_bf16 v[64:79], a[44:47], v[92:95], 0
    v_mfma_f32_32x32x16_bf16 v[48:63], a[36:39], v[88:91], v[48:63]
    v_mfma_f32_32x32x16_bf16 v[64:79], a[48:51], v[88:91], v[64:79]
    v_mfma_f32_32x32x16_bf16 v[48:63], a[40:43], v[12:15], v[48:63]
    v_mfma_f32_32x32x16_bf16 v[64:79], a[52:55], v[12:15], v[64:79]
    v_lshrrev_b32 v13, 9, v2
    v_lshlrev_b32 v13, 6, v13
    v_add_u32 v13, 160768, v13
    v_mfma_f32_32x32x16_bf16 v[16:31], a[12:15], v[140:143], v[16:31]
    ds_read_b128 a[12:15], v2 offset:3072
    s_waitcnt lgkmcnt(6)
    v_mfma_f32_32x32x16_bf16 v[16:31], a[16:19], v[144:147], v[16:31]
    ds_read_b128 a[16:19], v2 offset:4096
    s_nop 2
    v_max3_f32 v8, v48, v49, v50
    v_min3_f32 v10, v48, v49, v50
    v_max3_f32 v9, v51, v52, v53
    v_min3_f32 v11, v51, v52, v53
    v_max3_f32 v8, v8, v54, v55
    v_min3_f32 v10, v10, v54, v55
    v_max3_f32 v9, v9, v56, v57
    v_mfma_f32_32x32x16_bf16 v[16:31], a[20:23], v[148:151], v[16:31]
    ds_read_b128 a[20:23], v2 offset:5120
    s_waitcnt vmcnt(16)
    v_mfma_f32_32x32x16_bf16 v[96:111], a[88:91], a[56:59], 0
    v_mfma_f32_32x32x16_bf16 v[96:111], a[88:91], a[60:63], v[96:111]
    s_waitcnt vmcnt(14)
    v_mfma_f32_32x32x16_bf16 v[96:111], a[88:91], a[64:67], v[96:111]
    v_min_u32 v0, 112, v2
    v_lshlrev_b32 v0, 3, v0
    buffer_load_dwordx2 v[0:1], v0, s[4:7], s77 offen offset:0 sc1
    s_add_u32 s61, s54, 0
    v_mfma_f32_32x32x16_bf16 v[96:111], a[88:91], a[68:71], v[96:111]
    s_and_b32 s61, s61, 3
    s_lshl_b32 s61, s61, 10
    v_add_u32 v88, s61, v2
    s_add_u32 s61, s54, 1
    s_and_b32 s61, s61, 3
    s_lshl_b32 s61, s61, 10
    s_waitcnt lgkmcnt(6)
    v_mfma_f32_32x32x16_bf16 v[16:31], a[24:27], v[152:155], v[16:31]
    ds_read_b128 a[24:27], v2 offset:6144
    v_add_u32 v89, s61, v2
    s_add_u32 s61, s54, 2
    s_and_b32 s61, s61, 3
    s_lshl_b32 s61, s61, 10
    v_add_u32 v90, s61, v2
    s_add_u32 s61, s54, 3
    s_and_b32 s61, s61, 3
    v_mfma_f32_32x32x16_bf16 v[16:31], a[28:31], v[156:159], v[16:31]
    ds_read_b128 a[28:31], v2 offset:7168
    s_lshl_b32 s61, s61, 10
    v_add_u32 v91, s61, v2
    s_waitcnt vmcnt(13)
    v_mfma_f32_32x32x16_bf16 v[96:111], a[88:91], a[72:75], v[96:111]
    v_mfma_f32_32x32x16_bf16 v[96:111], a[88:91], a[76:79], v[96:111]
    s_waitcnt vmcnt(11)
    v_mfma_f32_32x32x16_bf16 v[96:111], a[88:91], a[80:83], v[96:111]
    v_mfma_f32_32x32x16_bf16 v[96:111], a[88:91], a[84:87], v[96:111]
    s_waitcnt vmcnt(9)
    v_mfma_f32_32x32x16_bf16 v[96:111], a[88:91], a[212:215], v[96:111]
    v_mfma_f32_32x32x16_bf16 v[96:111], a[88:91], a[216:219], v[96:111]
    s_waitcnt vmcnt(7)
    v_mfma_f32_32x32x16_bf16 v[96:111], a[88:91], a[220:223], v[96:111]
    v_mfma_f32_32x32x16_bf16 v[96:111], a[88:91], a[224:227], v[96:111]
    s_waitcnt vmcnt(5)
    v_mfma_f32_32x32x16_bf16 v[96:111], a[88:91], a[228:231], v[96:111]
    v_mfma_f32_32x32x16_bf16 v[96:111], a[88:91], a[232:235], v[96:111]
    s_waitcnt vmcnt(0)
    v_cmp_ne_u64 vcc, s[58:59], v[0:1]
    s_nop 0
    s_cbranch_vccnz L_p6_retry
L_p6_ok:
    v_mfma_f32_32x32x16_bf16 v[96:111], a[88:91], a[236:239], v[96:111]
    buffer_load_dwordx4 v[112:115], v89, s[4:7], s72 offen sc1
    v_mfma_f32_32x32x16_bf16 v[96:111], a[88:91], a[240:243], v[96:111]
    buffer_load_dwordx4 v[116:119], v90, s[4:7], s72 offen sc1
    v_accvgpr_read_b32 v7, a254
    v_accvgpr_read_b32 v3, a255
    v_and_b32 v7, 0xfffff, v7
    s_waitcnt lgkmcnt(6)
    v_mfma_f32_32x32x16_bf16 v[16:31], a[0:3], v[160:163], v[16:31]
    s_barrier
    ds_read_b128 a[0:3], v2 offset:8192
    buffer_load_dwordx4 v[120:123], v91, s[4:7], s72 offen sc1
    s_add_u32 s64, s66, 245760
    s_add_u32 s65, s64, 4096
    v_mfma_f32_32x32x16_bf16 v[16:31], a[4:7], v[164:167], v[16:31]
    ds_read_b128 a[4:7], v2 offset:9216
    buffer_load_dwordx4 v[124:127], v88, s[4:7], s72 offen sc1
    buffer_load_dwordx4 v[128:131], v89, s[4:7], s73 offen sc1
    v_cvt_pk_bf16_f32 v96, v96, v97
    s_waitcnt lgkmcnt(6)
    v_mfma_f32_32x32x16_bf16 v[16:31], a[8:11], v[168:171], v[16:31]
    ds_read_b128 a[8:11], v2 offset:10240
    buffer_load_dwordx4 v[132:135], v90, s[4:7], s73 offen sc1
    buffer_load_dwordx4 v[136:139], v91, s[4:7], s73 offen sc1
    v_mfma_f32_32x32x16_bf16 v[16:31], a[12:15], v[172:175], v[16:31]
    ds_read_b128 a[12:15], v2 offset:11264
    buffer_load_dwordx4 v[140:143], v88, s[4:7], s73 offen sc1
    v_cvt_pk_bf16_f32 v97, v98, v99
    v_cvt_pk_bf16_f32 v98, v100, v101
    v_cvt_pk_bf16_f32 v99, v102, v103
    v_min3_f32 v11, v11, v56, v57
    s_waitcnt lgkmcnt(6)
    v_mfma_f32_32x32x16_bf16 v[16:31], a[16:19], v[176:179], v[16:31]
    ds_read_b128 a[16:19], v2 offset:12288
    ds_write_b128 v7, v[96:99]
    buffer_load_dwordx4 a[212:215], v2, s[4:7], s64 offen offset:0 sc1
    v_mfma_f32_32x32x16_bf16 v[16:31], a[20:23], v[180:183], v[16:31]
    ds_read_b128 a[20:23], v2 offset:13312
    v_max3_f32 v8, v8, v58, v59
    v_min3_f32 v10, v10, v58, v59
    v_max3_f32 v9, v9, v60, v61
    v_min3_f32 v11, v11, v60, v61
    v_max3_f32 v8, v8, v62, v63
    v_min3_f32 v10, v10, v62, v63
    v_max3_f32 v9, v9, v64, v65
    v_min3_f32 v11, v11, v64, v65
    s_waitcnt lgkmcnt(7)
    v_mfma_f32_32x32x16_bf16 v[16:31], a[24:27], v[184:187], v[16:31]
    ds_read_b128 a[24:27], v2 offset:14336
    buffer_load_dwordx4 a[216:219], v2, s[4:7], s64 offen offset:1024 sc1
    v_max3_f32 v8, v8, v66, v67
    v_min3_f32 v10, v10, v66, v67
    v_max_f32 v8, v8, v9
    v_mfma_f32_32x32x16_bf16 v[16:31], a[28:31], v[188:191], v[16:31]
    ds_read_b128 a[28:31], v2 offset:15360
    s_bfm_b64 exec, 8, 0
    buffer_store_dwordx4 a[252:255], v2, s[4:7], s32 offen sc1
    s_mov_b64 exec, -1
    s_add_u32 s32, s32, 2048
    v_min_f32 v10, v10, v11
    s_waitcnt lgkmcnt(7)
    v_mfma_f32_32x32x16_bf16 v[16:31], a[0:3], v[192:195], v[16:31]
    s_barrier
    ds_read_b128 a[0:3], v2 offset:16384
    s_waitcnt lgkmcnt(4)
    s_barrier
    ds_read_b128 a[52:55], v3 offset:0
    ds_read_b128 a[56:59], v3 offset:256
    ds_read_b128 a[60:63], v3 offset:512
    ds_read_b128 a[64:67], v3 offset:768
    v_mfma_f32_32x32x16_bf16 v[16:31], a[4:7], v[196:199], v[16:31]
    ds_read_b128 a[4:7], v2 offset:17408
    ds_read_b128 a[68:71], v3 offset:1024
    ds_read_b128 a[72:75], v3 offset:1280
    ds_read_b128 a[76:79], v3 offset:1536
    ds_read_b128 a[80:83], v3 offset:1792
    ds_read_b128 a[84:87], v3 offset:2048
    ds_read_b128 a[88:91], v3 offset:2304
    v_mul_f32 v8, v4, v8
    v_mul_f32 v10, v4, v10
    v_pk_fma_f32 v[68:69], v[48:49], v[4:5], v[10:11] op_sel_hi:[1,0,0] neg_lo:[1,0,0] neg_hi:[1,0,0]
    v_pk_fma_f32 v[48:49], v[48:49], v[4:5], v[8:9] op_sel_hi:[1,0,0] neg_lo:[0,0,1] neg_hi:[0,0,1]
    v_pk_fma_f32 v[70:71], v[50:51], v[4:5], v[10:11] op_sel_hi:[1,0,0] neg_lo:[1,0,0] neg_hi:[1,0,0]
    v_pk_fma_f32 v[50:51], v[50:51], v[4:5], v[8:9] op_sel_hi:[1,0,0] neg_lo:[0,0,1] neg_hi:[0,0,1]
    v_pk_fma_f32 v[72:73], v[52:53], v[4:5], v[10:11] op_sel_hi:[1,0,0] neg_lo:[1,0,0] neg_hi:[1,0,0]
    v_pk_fma_f32 v[52:53], v[52:53], v[4:5], v[8:9] op_sel_hi:[1,0,0] neg_lo:[0,0,1] neg_hi:[0,0,1]
    v_pk_fma_f32 v[74:75], v[54:55], v[4:5], v[10:11] op_sel_hi:[1,0,0] neg_lo:[1,0,0] neg_hi:[1,0,0]
    v_pk_fma_f32 v[54:55], v[54:55], v[4:5], v[8:9] op_sel_hi:[1,0,0] neg_lo:[0,0,1] neg_hi:[0,0,1]
    v_pk_fma_f32 v[76:77], v[56:57], v[4:5], v[10:11] op_sel_hi:[1,0,0] neg_lo:[1,0,0] neg_hi:[1,0,0]
    v_pk_fma_f32 v[56:57], v[56:57], v[4:5], v[8:9] op_sel_hi:[1,0,0] neg_lo:[0,0,1] neg_hi:[0,0,1]
    v_pk_fma_f32 v[78:79], v[58:59], v[4:5], v[10:11] op_sel_hi:[1,0,0] neg_lo:[1,0,0] neg_hi:[1,0,0]
    v_pk_fma_f32 v[58:59], v[58:59], v[4:5], v[8:9] op_sel_hi:[1,0,0] neg_lo:[0,0,1] neg_hi:[0,0,1]
    v_pk_fma_f32 v[80:81], v[60:61], v[4:5], v[10:11] op_sel_hi:[1,0,0] neg_lo:[1,0,0] neg_hi:[1,0,0]
    v_pk_fma_f32 v[60:61], v[60:61], v[4:5], v[8:9] op_sel_hi:[1,0,0] neg_lo:[0,0,1] neg_hi:[0,0,1]
    v_pk_fma_f32 v[82:83], v[62:63], v[4:5], v[10:11] op_sel_hi:[1,0,0] neg_lo:[1,0,0] neg_hi:[1,0,0]
    v_pk_fma_f32 v[62:63], v[62:63], v[4:5], v[8:9] op_sel_hi:[1,0,0] neg_lo:[0,0,1] neg_hi:[0,0,1]
    v_pk_fma_f32 v[84:85], v[64:65], v[4:5], v[10:11] op_sel_hi:[1,0,0] neg_lo:[1,0,0] neg_hi:[1,0,0]
    v_pk_fma_f32 v[64:65], v[64:65], v[4:5], v[8:9] op_sel_hi:[1,0,0] neg_lo:[0,0,1] neg_hi:[0,0,1]
    v_pk_fma_f32 v[86:87], v[66:67], v[4:5], v[10:11] op_sel_hi:[1,0,0] neg_lo:[1,0,0] neg_hi:[1,0,0]
    v_pk_fma_f32 v[66:67], v[66:67], v[4:5], v[8:9] op_sel_hi:[1,0,0] neg_lo:[0,0,1] neg_hi:[0,0,1]
    v_mfma_f32_32x32x16_bf16 v[16:31], a[8:11], v[200:203], v[16:31]
    ds_read_b128 a[8:11], v2 offset:18432
    buffer_load_dwordx4 a[220:223], v2, s[4:7], s64 offen offset:2048 sc1
    v_exp_f32 v68, v68
    v_exp_f32 v48, v48
    v_mfma_f32_32x32x16_bf16 v[16:31], a[12:15], v[204:207], v[16:31]
    ds_read_b128 a[12:15], v2 offset:19456
    v_exp_f32 v69, v69
    v_exp_f32 v49, v49
    v_exp_f32 v70, v70
    v_exp_f32 v50, v50
    s_waitcnt lgkmcnt(15)
    v_mfma_f32_32x32x16_bf16 v[16:31], a[16:19], v[208:211], v[16:31]
    ds_read_b128 a[16:19], v2 offset:20480
    buffer_load_dwordx4 a[224:227], v2, s[4:7], s64 offen offset:3072 sc1
    v_exp_f32 v71, v71
    v_lshrrev_b32 v198, 8, v2
    v_mfma_f32_32x32x16_bf16 v[16:31], a[20:23], v[212:215], v[16:31]
    ds_read_b128 a[20:23], v2 offset:21504
    v_exp_f32 v51, v51
    v_exp_f32 v72, v72
    v_exp_f32 v52, v52
    v_exp_f32 v73, v73
    s_waitcnt lgkmcnt(15)
    v_mfma_f32_32x32x16_bf16 v[16:31], a[24:27], v[216:219], v[16:31]
    ds_read_b128 a[24:27], v2 offset:22528
    buffer_load_dwordx4 a[228:231], v2, s[4:7], s65 offen offset:0 sc1
    v_exp_f32 v53, v53
    v_mul_u32_u24 v198, 40, v198
    v_mfma_f32_32x32x16_bf16 v[16:31], a[28:31], v[220:223], v[16:31]
    ds_read_b128 a[28:31], v2 offset:23552
    v_exp_f32 v74, v74
    v_exp_f32 v54, v54
    v_exp_f32 v75, v75
    v_exp_f32 v55, v55
    s_waitcnt lgkmcnt(12)
    v_mfma_f32_32x32x16_bf16 v[16:31], a[0:3], v[224:227], v[16:31]
    s_add_u32 s64, s67, 245760
    s_add_u32 s65, s64, 4096
    buffer_load_dwordx4 a[232:235], v2, s[4:7], s64 offen offset:0 sc1
    v_exp_f32 v76, v76
    v_mfma_f32_32x32x16_bf16 v[16:31], a[4:7], v[228:231], v[16:31]
    v_exp_f32 v56, v56
    v_exp_f32 v77, v77
    v_exp_f32 v57, v57
    v_exp_f32 v78, v78
    v_bfe_u32 v15, v2, 4, 4
    s_waitcnt lgkmcnt(4)
    v_mfma_f32_32x32x16_bf16 v[16:31], a[8:11], v[232:235], v[16:31]
    buffer_load_dwordx4 a[236:239], v2, s[4:7], s64 offen offset:1024 sc1
    v_exp_f32 v58, v58
    v_exp_f32 v79, v79
    v_mfma_f32_32x32x16_bf16 v[16:31], a[12:15], v[236:239], v[16:31]
    v_exp_f32 v59, v59
    v_exp_f32 v80, v80
    v_exp_f32 v60, v60
    v_exp_f32 v81, v81
    v_mul_u32_u24 v199, 288, v15
    s_waitcnt lgkmcnt(2)
    v_mfma_f32_32x32x16_bf16 v[16:31], a[16:19], v[240:243], v[16:31]
    buffer_load_dwordx4 a[240:243], v2, s[4:7], s64 offen offset:2048 sc1
    v_exp_f32 v61, v61
    v_exp_f32 v82, v82
    v_mfma_f32_32x32x16_bf16 v[16:31], a[20:23], v[244:247], v[16:31]
    v_exp_f32 v62, v62
    v_exp_f32 v83, v83
    v_exp_f32 v63, v63
    v_exp_f32 v84, v84
    v_lshrrev_b32 v200, 2, v15
    s_waitcnt lgkmcnt(0)
    v_mfma_f32_32x32x16_bf16 v[16:31], a[24:27], v[248:251], v[16:31]
    buffer_load_dwordx4 a[244:247], v2, s[4:7], s64 offen offset:3072 sc1
    v_exp_f32 v64, v64
    v_exp_f32 v85, v85
    v_mfma_f32_32x32x16_bf16 v[16:31], a[28:31], v[252:255], v[16:31]
    v_exp_f32 v65, v65
    v_exp_f32 v86, v86
    v_exp_f32 v66, v66
    v_exp_f32 v87, v87
    v_mul_u32_u24 v200, 112, v200
    v_min_u32 v0, 112, v2
    v_lshlrev_b32 v0, 3, v0
    buffer_load_dwordx2 v[0:1], v0, s[4:7], s77 offen offset:2048 sc1
    buffer_load_dwordx4 a[0:3], v89, s[4:7], s74 offen sc1
    buffer_load_dwordx4 a[4:7], v90, s[4:7], s74 offen sc1
    buffer_load_dwordx4 a[8:11], v91, s[4:7], s74 offen sc1
    buffer_load_dwordx4 a[12:15], v88, s[4:7], s74 offen sc1
    buffer_load_dwordx4 a[16:19], v89, s[4:7], s75 offen sc1
    buffer_load_dwordx4 a[20:23], v90, s[4:7], s75 offen sc1
    buffer_load_dwordx4 a[24:27], v91, s[4:7], s75 offen sc1
    buffer_load_dwordx4 a[28:31], v88, s[4:7], s75 offen sc1
    v_exp_f32 v67, v67
    v_pk_add_f32 v[10:11], v[68:69], v[70:71]
    v_pk_add_f32 v[8:9], v[48:49], v[50:51]
    v_pk_add_f32 v[10:11], v[10:11], v[72:73]
    v_pk_add_f32 v[8:9], v[8:9], v[52:53]
    v_pk_add_f32 v[10:11], v[10:11], v[74:75]
    v_pk_add_f32 v[8:9], v[8:9], v[54:55]
    v_pk_add_f32 v[10:11], v[10:11], v[76:77]
    v_pk_add_f32 v[8:9], v[8:9], v[56:57]
    v_pk_add_f32 v[10:11], v[10:11], v[78:79]
    v_pk_add_f32 v[8:9], v[8:9], v[58:59]
    v_pk_add_f32 v[10:11], v[10:11], v[80:81]
    v_pk_add_f32 v[8:9], v[8:9], v[60:61]
    v_pk_add_f32 v[10:11], v[10:11], v[82:83]
    v_pk_add_f32 v[8:9], v[8:9], v[62:63]
    v_pk_add_f32 v[10:11], v[10:11], v[84:85]
    v_pk_add_f32 v[8:9], v[8:9], v[64:65]
    v_pk_add_f32 v[10:11], v[10:11], v[86:87]
    v_pk_add_f32 v[8:9], v[8:9], v[66:67]
    v_add_f32 v10, v10, v11
    v_add_f32 v8, v8, v9
    v_rcp_f32 v10, v10
    v_mul_f32 v12, 0x358637bd, v8
    v_mul_f32 v10, v10, v8
    v_pk_mul_f32 v[68:69], v[68:69], v[10:11] op_sel_hi:[1,0]
    v_pk_mul_f32 v[70:71], v[70:71], v[10:11] op_sel_hi:[1,0]
    v_pk_mul_f32 v[72:73], v[72:73], v[10:11] op_sel_hi:[1,0]
    v_pk_mul_f32 v[74:75], v[74:75], v[10:11] op_sel_hi:[1,0]
    v_pk_mul_f32 v[76:77], v[76:77], v[10:11] op_sel_hi:[1,0]
    v_pk_mul_f32 v[78:79], v[78:79], v[10:11] op_sel_hi:[1,0]
    v_pk_mul_f32 v[80:81], v[80:81], v[10:11] op_sel_hi:[1,0]
    v_pk_mul_f32 v[82:83], v[82:83], v[10:11] op_sel_hi:[1,0]
    v_pk_mul_f32 v[84:85], v[84:85], v[10:11] op_sel_hi:[1,0]
    v_pk_mul_f32 v[86:87], v[86:87], v[10:11] op_sel_hi:[1,0]
    v_cvt_pk_bf16_f32 v48, v48, v49
    v_cvt_pk_bf16_f32 v49, v50, v51
    v_cvt_pk_bf16_f32 v50, v52, v53
    v_cvt_pk_bf16_f32 v51, v54, v55
    v_cvt_pk_bf16_f32 v52, v56, v57
    v_cvt_pk_bf16_f32 v53, v58, v59
    v_cvt_pk_bf16_f32 v54, v60, v61
    v_cvt_pk_bf16_f32 v55, v62, v63
    v_cvt_pk_bf16_f32 v56, v64, v65
    v_cvt_pk_bf16_f32 v57, v66, v67
    v_cvt_pk_bf16_f32 v58, v68, v69
    v_cvt_pk_bf16_f32 v59, v70, v71
    v_cvt_pk_bf16_f32 v60, v72, v73
    v_cvt_pk_bf16_f32 v61, v74, v75
    v_cvt_pk_bf16_f32 v62, v76, v77
    v_cvt_pk_bf16_f32 v63, v78, v79
    v_cvt_pk_bf16_f32 v64, v80, v81
    v_cvt_pk_bf16_f32 v65, v82, v83
    v_cvt_pk_bf16_f32 v66, v84, v85
    v_cvt_pk_bf16_f32 v67, v86, v87
    v_mfma_f32_32x32x16_bf16 v[96:111], a[56:59], v[48:51], 0
    ds_read_b128 v[240:243], v13 offset:256
    ds_read_b128 v[244:247], v13 offset:272
    s_waitcnt lgkmcnt(1)
    v_fma_f32 v16, v16, v5, v240
    v_fma_f32 v17, v17, v5, v241
    v_fma_f32 v18, v18, v5, v242
    v_mfma_f32_32x32x16_bf16 v[32:47], a[52:55], v[48:51], 0
    v_fma_f32 v19, v19, v5, v243
    ds_read_b128 v[240:243], v13 offset:288
    v_max_f32 v16, 0, v16
    v_max_f32 v17, 0, v17
    v_max_f32 v18, 0, v18
    v_max_f32 v19, 0, v19
    v_mfma_f32_32x32x16_bf16 v[96:111], a[64:67], v[52:55], v[96:111]
    v_mul_f32 v16, v16, v16
    v_mul_f32 v17, v17, v17
    v_mul_f32 v18, v18, v18
    v_mul_f32 v19, v19, v19
    v_cvt_pk_bf16_f32 v16, v16, v17
    v_cvt_pk_bf16_f32 v17, v18, v19
    v_mfma_f32_32x32x16_bf16 v[32:47], a[60:63], v[52:55], v[32:47]
    s_waitcnt lgkmcnt(1)
    v_fma_f32 v20, v20, v5, v244
    v_fma_f32 v21, v21, v5, v245
    v_fma_f32 v22, v22, v5, v246
    v_fma_f32 v23, v23, v5, v247
    ds_read_b128 v[244:247], v13 offset:304
    v_mfma_f32_32x32x16_bf16 v[96:111], a[72:75], v[56:59], v[96:111]
    v_max_f32 v20, 0, v20
    v_max_f32 v21, 0, v21
    v_max_f32 v22, 0, v22
    v_max_f32 v23, 0, v23
    v_mul_f32 v20, v20, v20
    v_mul_f32 v21, v21, v21
    v_mfma_f32_32x32x16_bf16 v[32:47], a[68:71], v[56:59], v[32:47]
    v_mul_f32 v22, v22, v22
    v_mul_f32 v23, v23, v23
    v_cvt_pk_bf16_f32 v18, v20, v21
    v_cvt_pk_bf16_f32 v19, v22, v23
    s_waitcnt lgkmcnt(1)
    v_fma_f32 v24, v24, v5, v240
    v_mfma_f32_32x32x16_bf16 v[96:111], a[80:83], v[60:63], v[96:111]
    v_fma_f32 v25, v25, v5, v241
    v_fma_f32 v26, v26, v5, v242
    v_fma_f32 v27, v27, v5, v243
    v_max_f32 v24, 0, v24
    v_max_f32 v25, 0, v25
    v_max_f32 v26, 0, v26
    v_mfma_f32_32x32x16_bf16 v[32:47], a[76:79], v[60:63], v[32:47]
    v_max_f32 v27, 0, v27
    v_mul_f32 v24, v24, v24
    v_mul_f32 v25, v25, v25
    v_mul_f32 v26, v26, v26
    v_mul_f32 v27, v27, v27
    v_cvt_pk_bf16_f32 v20, v24, v25
    v_mfma_f32_32x32x16_bf16 v[96:111], a[88:91], v[64:67], v[96:111]
    v_cvt_pk_bf16_f32 v21, v26, v27
    s_waitcnt lgkmcnt(0)
    v_fma_f32 v28, v28, v5, v244
    v_fma_f32 v29, v29, v5, v245
    v_fma_f32 v30, v30, v5, v246
    v_fma_f32 v31, v31, v5, v247
    v_mfma_f32_32x32x16_bf16 v[32:47], a[84:87], v[64:67], v[32:47]
    v_max_f32 v28, 0, v28
    v_max_f32 v29, 0, v29
    v_max_f32 v30, 0, v30
    v_max_f32 v31, 0, v31
    v_mul_f32 v28, v28, v28
    v_mul_f32 v29, v29, v29
    v_mul_f32 v30, v30, v30
    v_mul_f32 v31, v31, v31
    v_cvt_pk_bf16_f32 v22, v28, v29
    v_cvt_pk_bf16_f32 v23, v30, v31
    v_add_f32 v8, v100, v12
    v_rcp_f32 v8, v8
    s_nop 0
    v_mul_f32 v96, v96, v8
    v_mul_f32 v97, v97, v8
    v_mul_f32 v98, v98, v8
    v_mul_f32 v99, v99, v8
    v_cvt_pk_bf16_f32 v96, v96, v97
    v_cvt_pk_bf16_f32 v97, v98, v99
    v_mul_f32 v32, v32, v8
    v_mul_f32 v33, v33, v8
    v_mul_f32 v34, v34, v8
    v_mul_f32 v35, v35, v8
    v_mul_f32 v36, v36, v8
    v_mul_f32 v37, v37, v8
    v_mul_f32 v38, v38, v8
    v_mul_f32 v39, v39, v8
    v_mul_f32 v40, v40, v8
    v_mul_f32 v41, v41, v8
    v_mul_f32 v42, v42, v8
    v_mul_f32 v43, v43, v8
    v_mul_f32 v44, v44, v8
    v_mul_f32 v45, v45, v8
    v_mul_f32 v46, v46, v8
    v_mul_f32 v47, v47, v8
    v_permlane32_swap_b32 v96, v98
    v_permlane32_swap_b32 v97, v99
    v_cvt_pk_bf16_f32 v32, v32, v33
    v_cvt_pk_bf16_f32 v33, v34, v35
    v_cvt_pk_bf16_f32 v34, v36, v37
    v_cvt_pk_bf16_f32 v35, v38, v39
    v_cvt_pk_bf16_f32 v36, v40, v41
    v_cvt_pk_bf16_f32 v37, v42, v43
    v_cvt_pk_bf16_f32 v38, v44, v45
    v_cvt_pk_bf16_f32 v39, v46, v47
    buffer_store_dwordx4 v[16:19], v6, s[4:7], s30 offen offset:0 sc1
    buffer_store_dwordx4 v[20:23], v6, s[4:7], s30 offen offset:256 sc1
    s_add_u32 s30, s30, 65536
    buffer_store_dwordx4 v[32:35], v6, s[4:7], s80 offen sc1
    buffer_store_dwordx4 v[36:39], v6, s[4:7], s80 offen offset:256 sc1
    s_mov_b32 exec_hi, 0
    buffer_store_dwordx4 v[96:99], v6, s[4:7], s38 offen sc1
    s_mov_b32 exec_hi, -1
    v_sub_u32 v199, v199, v200
    v_add3_u32 v199, v199, v198, s70
    v_mul_u32_u24 v15, 1280, v15
    v_add_u32 v15, v15, v198
    v_add_u32 v198, 161280, v198
    ds_read_b64 v[176:177], v199 offset:0
    ds_read_b64 v[178:179], v199 offset:8
    ds_read_b64 v[180:181], v199 offset:16
    ds_read_b64 v[182:183], v199 offset:24
    ds_read_b64 v[184:185], v199 offset:32
    ds_read_b64 v[188:189], v198 offset:0
    ds_read_b64 v[190:191], v198 offset:8
    ds_read_b64 v[192:193], v198 offset:16
    ds_read_b64 v[194:195], v198 offset:24
    ds_read_b64 v[196:197], v198 offset:32
    s_waitcnt lgkmcnt(0)
    v_lshlrev_b32 v200, 16, v176
    v_and_b32 v201, 0xffff0000, v176
    v_lshlrev_b32 v202, 16, v188
    v_and_b32 v203, 0xffff0000, v188
    v_add_f32 v156, v200, v202
    v_add_f32 v157, v201, v203
    v_lshlrev_b32 v200, 16, v177
    v_and_b32 v201, 0xffff0000, v177
    v_lshlrev_b32 v202, 16, v189
    v_and_b32 v203, 0xffff0000, v189
    v_add_f32 v158, v200, v202
    v_add_f32 v159, v201, v203
    v_lshlrev_b32 v200, 16, v178
    v_and_b32 v201, 0xffff0000, v178
    v_lshlrev_b32 v202, 16, v190
    v_and_b32 v203, 0xffff0000, v190
    v_add_f32 v160, v200, v202
    v_add_f32 v161, v201, v203
    v_lshlrev_b32 v200, 16, v179
    v_and_b32 v201, 0xffff0000, v179
    v_lshlrev_b32 v202, 16, v191
    v_and_b32 v203, 0xffff0000, v191
    v_add_f32 v162, v200, v202
    v_add_f32 v163, v201, v203
    v_lshlrev_b32 v200, 16, v180
    v_and_b32 v201, 0xffff0000, v180
    v_lshlrev_b32 v202, 16, v192
    v_and_b32 v203, 0xffff0000, v192
    v_add_f32 v164, v200, v202
    v_add_f32 v165, v201, v203
    v_lshlrev_b32 v200, 16, v181
    v_and_b32 v201, 0xffff0000, v181
    v_lshlrev_b32 v202, 16, v193
    v_and_b32 v203, 0xffff0000, v193
    v_add_f32 v166, v200, v202
    v_add_f32 v167, v201, v203
    v_lshlrev_b32 v200, 16, v182
    v_and_b32 v201, 0xffff0000, v182
    v_lshlrev_b32 v202, 16, v194
    v_and_b32 v203, 0xffff0000, v194
    v_add_f32 v168, v200, v202
    v_add_f32 v169, v201, v203
    v_lshlrev_b32 v200, 16, v183
    v_and_b32 v201, 0xffff0000, v183
    v_lshlrev_b32 v202, 16, v195
    v_and_b32 v203, 0xffff0000, v195
    v_add_f32 v170, v200, v202
    v_add_f32 v171, v201, v203
    v_lshlrev_b32 v200, 16, v184
    v_and_b32 v201, 0xffff0000, v184
    v_lshlrev_b32 v202, 16, v196
    v_and_b32 v203, 0xffff0000, v196
    v_add_f32 v172, v200, v202
    v_add_f32 v173, v201, v203
    v_lshlrev_b32 v200, 16, v185
    v_and_b32 v201, 0xffff0000, v185
    v_lshlrev_b32 v202, 16, v197
    v_and_b32 v203, 0xffff0000, v197
    v_add_f32 v174, v200, v202
    v_add_f32 v175, v201, v203
    buffer_load_dwordx4 a[248:251], v2, s[4:7], s65 offen offset:0 sc1
    s_add_u32 s64, s68, 327680
    s_add_u32 s65, s64, 4096
    buffer_load_dwordx4 a[32:35], v2, s[4:7], s64 offen offset:0 sc1
    buffer_load_dwordx4 a[36:39], v2, s[4:7], s64 offen offset:1024 sc1
    buffer_load_dwordx4 a[40:43], v2, s[4:7], s64 offen offset:2048 sc1
    buffer_load_dwordx4 a[44:47], v2, s[4:7], s64 offen offset:3072 sc1
    buffer_load_dwordx4 a[48:51], v2, s[4:7], s65 offen offset:0 sc1
    s_barrier
    s_waitcnt vmcnt(34)
    v_mfma_f32_16x16x32_bf16 v[196:199], a[92:95], v[112:115], 0
    v_mfma_f32_16x16x32_bf16 v[200:203], a[96:99], v[112:115], 0
    v_mfma_f32_16x16x32_bf16 v[204:207], a[100:103], v[112:115], 0
    v_mfma_f32_16x16x32_bf16 v[208:211], a[104:107], v[112:115], 0
    v_mfma_f32_16x16x32_bf16 v[212:215], a[108:111], v[112:115], 0
    v_mfma_f32_16x16x32_bf16 v[216:219], a[92:95], v[116:119], 0
    v_mfma_f32_16x16x32_bf16 v[220:223], a[96:99], v[116:119], 0
    v_mfma_f32_16x16x32_bf16 v[224:227], a[100:103], v[116:119], 0
    v_mfma_f32_16x16x32_bf16 v[228:231], a[104:107], v[116:119], 0
    v_mfma_f32_16x16x32_bf16 v[232:235], a[108:111], v[116:119], 0
    v_mfma_f32_16x16x32_bf16 v[236:239], a[92:95], v[120:123], 0
    v_mfma_f32_16x16x32_bf16 v[240:243], a[96:99], v[120:123], 0
    v_mfma_f32_16x16x32_bf16 v[244:247], a[100:103], v[120:123], 0
    v_mfma_f32_16x16x32_bf16 v[248:251], a[104:107], v[120:123], 0
    v_mfma_f32_16x16x32_bf16 v[252:255], a[108:111], v[120:123], 0
    v_mfma_f32_16x16x32_bf16 v[176:179], a[92:95], v[124:127], 0
    v_mfma_f32_16x16x32_bf16 v[180:183], a[96:99], v[124:127], 0
    v_mfma_f32_16x16x32_bf16 v[184:187], a[100:103], v[124:127], 0
    v_mfma_f32_16x16x32_bf16 v[188:191], a[104:107], v[124:127], 0
    v_mfma_f32_16x16x32_bf16 v[192:195], a[108:111], v[124:127], 0
    s_waitcnt vmcnt(30)
    v_mfma_f32_16x16x32_bf16 v[196:199], a[112:115], v[128:131], v[196:199]
    v_mfma_f32_16x16x32_bf16 v[200:203], a[116:119], v[128:131], v[200:203]
    v_mfma_f32_16x16x32_bf16 v[204:207], a[120:123], v[128:131], v[204:207]
    v_mfma_f32_16x16x32_bf16 v[208:211], a[124:127], v[128:131], v[208:211]
    v_mfma_f32_16x16x32_bf16 v[212:215], a[128:131], v[128:131], v[212:215]
    v_mfma_f32_16x16x32_bf16 v[216:219], a[112:115], v[132:135], v[216:219]
    v_mfma_f32_16x16x32_bf16 v[220:223], a[116:119], v[132:135], v[220:223]
    v_mfma_f32_16x16x32_bf16 v[224:227], a[120:123], v[132:135], v[224:227]
    v_mfma_f32_16x16x32_bf16 v[228:231], a[124:127], v[132:135], v[228:231]
    v_mfma_f32_16x16x32_bf16 v[232:235], a[128:131], v[132:135], v[232:235]
    v_mfma_f32_16x16x32_bf16 v[236:239], a[112:115], v[136:139], v[236:239]
    v_mfma_f32_16x16x32_bf16 v[240:243], a[116:119], v[136:139], v[240:243]
    v_mfma_f32_16x16x32_bf16 v[244:247], a[120:123], v[136:139], v[244:247]
    v_mfma_f32_16x16x32_bf16 v[248:251], a[124:127], v[136:139], v[248:251]
    v_mfma_f32_16x16x32_bf16 v[252:255], a[128:131], v[136:139], v[252:255]
    v_mfma_f32_16x16x32_bf16 v[176:179], a[112:115], v[140:143], v[176:179]
    v_mfma_f32_16x16x32_bf16 v[180:183], a[116:119], v[140:143], v[180:183]
    v_mfma_f32_16x16x32_bf16 v[184:187], a[120:123], v[140:143], v[184:187]
    v_mfma_f32_16x16x32_bf16 v[188:191], a[124:127], v[140:143], v[188:191]
    v_mfma_f32_16x16x32_bf16 v[192:195], a[128:131], v[140:143], v[192:195]
    s_waitcnt vmcnt(6)
    s_bfm_b64 exec, 8, 0
    buffer_store_dwordx4 a[252:255], v2, s[4:7], s32 offen sc1
    s_mov_b64 exec, -1
    s_add_u32 s32, s32, 2048
    v_cmp_ne_u64 vcc, s[58:59], v[0:1]
    s_nop 0
    s_cbranch_vccnz L_p7_retry
L_p7_ok:
    s_add_u32 s72, s72, 65536
    buffer_load_dwordx4 v[68:71], v89, s[4:7], s72 offen sc1
    buffer_load_dwordx4 v[72:75], v90, s[4:7], s72 offen sc1
    buffer_load_dwordx4 v[76:79], v91, s[4:7], s72 offen sc1
    buffer_load_dwordx4 v[80:83], v88, s[4:7], s72 offen sc1
    v_mfma_f32_16x16x32_bf16 v[136:139], a[92:95], a[0:3], 0
    s_add_u32 s73, s73, 65536
    v_mfma_f32_16x16x32_bf16 v[140:143], a[96:99], a[0:3], 0
    buffer_load_dwordx4 a[52:55], v89, s[4:7], s73 offen sc1
    v_mfma_f32_16x16x32_bf16 v[144:147], a[100:103], a[0:3], 0
    buffer_load_dwordx4 a[56:59], v90, s[4:7], s73 offen sc1
    v_mfma_f32_16x16x32_bf16 v[148:151], a[104:107], a[0:3], 0
    buffer_load_dwordx4 a[60:63], v91, s[4:7], s73 offen sc1
    v_mfma_f32_16x16x32_bf16 v[152:155], a[108:111], a[0:3], 0
    buffer_load_dwordx4 a[64:67], v88, s[4:7], s73 offen sc1
    v_mfma_f32_16x16x32_bf16 v[116:119], a[92:95], a[4:7], 0
    v_mfma_f32_16x16x32_bf16 v[120:123], a[96:99], a[4:7], 0
    v_mfma_f32_16x16x32_bf16 v[124:127], a[100:103], a[4:7], 0
    v_mfma_f32_16x16x32_bf16 v[128:131], a[104:107], a[4:7], 0
    v_mfma_f32_16x16x32_bf16 v[132:135], a[108:111], a[4:7], 0
    v_mfma_f32_16x16x32_bf16 v[96:99], a[92:95], a[8:11], 0
    v_mfma_f32_16x16x32_bf16 v[100:103], a[96:99], a[8:11], 0
    v_mfma_f32_16x16x32_bf16 v[104:107], a[100:103], a[8:11], 0
    v_mfma_f32_16x16x32_bf16 v[108:111], a[104:107], a[8:11], 0
    v_mfma_f32_16x16x32_bf16 v[112:115], a[108:111], a[8:11], 0
    v_mfma_f32_16x16x32_bf16 v[156:159], a[92:95], a[12:15], v[156:159]
    v_mfma_f32_16x16x32_bf16 v[160:163], a[96:99], a[12:15], v[160:163]
    v_mfma_f32_16x16x32_bf16 v[164:167], a[100:103], a[12:15], v[164:167]
    v_mfma_f32_16x16x32_bf16 v[168:171], a[104:107], a[12:15], v[168:171]
    v_mfma_f32_16x16x32_bf16 v[172:175], a[108:111], a[12:15], v[172:175]
    v_mfma_f32_16x16x32_bf16 v[136:139], a[112:115], a[16:19], v[136:139]
    s_add_u32 s74, s74, 65536
    v_mfma_f32_16x16x32_bf16 v[140:143], a[116:119], a[16:19], v[140:143]
    buffer_load_dwordx4 a[68:71], v89, s[4:7], s74 offen sc1
    v_mfma_f32_16x16x32_bf16 v[144:147], a[120:123], a[16:19], v[144:147]
    buffer_load_dwordx4 a[72:75], v90, s[4:7], s74 offen sc1
    v_mfma_f32_16x16x32_bf16 v[148:151], a[124:127], a[16:19], v[148:151]
    buffer_load_dwordx4 a[76:79], v91, s[4:7], s74 offen sc1
    v_mfma_f32_16x16x32_bf16 v[152:155], a[128:131], a[16:19], v[152:155]
    buffer_load_dwordx4 a[80:83], v88, s[4:7], s74 offen sc1
    v_mfma_f32_16x16x32_bf16 v[116:119], a[112:115], a[20:23], v[116:119]
    v_mfma_f32_16x16x32_bf16 v[120:123], a[116:119], a[20:23], v[120:123]
    v_mfma_f32_16x16x32_bf16 v[124:127], a[120:123], a[20:23], v[124:127]
    v_mfma_f32_16x16x32_bf16 v[128:131], a[124:127], a[20:23], v[128:131]
    v_mfma_f32_16x16x32_bf16 v[132:135], a[128:131], a[20:23], v[132:135]
    v_mfma_f32_16x16x32_bf16 v[96:99], a[112:115], a[24:27], v[96:99]
    v_mfma_f32_16x16x32_bf16 v[100:103], a[116:119], a[24:27], v[100:103]
    v_mfma_f32_16x16x32_bf16 v[104:107], a[120:123], a[24:27], v[104:107]
    v_mfma_f32_16x16x32_bf16 v[108:111], a[124:127], a[24:27], v[108:111]
    v_mfma_f32_16x16x32_bf16 v[112:115], a[128:131], a[24:27], v[112:115]
    v_mfma_f32_16x16x32_bf16 v[156:159], a[112:115], a[28:31], v[156:159]
    v_mfma_f32_16x16x32_bf16 v[160:163], a[116:119], a[28:31], v[160:163]
    v_mfma_f32_16x16x32_bf16 v[164:167], a[120:123], a[28:31], v[164:167]
    v_mfma_f32_16x16x32_bf16 v[168:171], a[124:127], a[28:31], v[168:171]
    v_mfma_f32_16x16x32_bf16 v[172:175], a[128:131], a[28:31], v[172:175]
    s_waitcnt vmcnt(8)
    v_mfma_f32_16x16x32_bf16 v[196:199], a[132:135], v[68:71], v[196:199]
    s_add_u32 s75, s75, 65536
    v_mfma_f32_16x16x32_bf16 v[200:203], a[136:139], v[68:71], v[200:203]
    buffer_load_dwordx4 v[48:51], v89, s[4:7], s75 offen sc1
    v_mfma_f32_16x16x32_bf16 v[204:207], a[140:143], v[68:71], v[204:207]
    buffer_load_dwordx4 v[52:55], v90, s[4:7], s75 offen sc1
    v_mfma_f32_16x16x32_bf16 v[208:211], a[144:147], v[68:71], v[208:211]
    buffer_load_dwordx4 v[56:59], v91, s[4:7], s75 offen sc1
    v_mfma_f32_16x16x32_bf16 v[212:215], a[148:151], v[68:71], v[212:215]
    buffer_load_dwordx4 v[60:63], v88, s[4:7], s75 offen sc1
    v_mfma_f32_16x16x32_bf16 v[216:219], a[132:135], v[72:75], v[216:219]
    v_mfma_f32_16x16x32_bf16 v[220:223], a[136:139], v[72:75], v[220:223]
    v_mfma_f32_16x16x32_bf16 v[224:227], a[140:143], v[72:75], v[224:227]
    v_mfma_f32_16x16x32_bf16 v[228:231], a[144:147], v[72:75], v[228:231]
    v_mfma_f32_16x16x32_bf16 v[232:235], a[148:151], v[72:75], v[232:235]
    v_mfma_f32_16x16x32_bf16 v[236:239], a[132:135], v[76:79], v[236:239]
    v_mfma_f32_16x16x32_bf16 v[240:243], a[136:139], v[76:79], v[240:243]
    v_mfma_f32_16x16x32_bf16 v[244:247], a[140:143], v[76:79], v[244:247]
    v_mfma_f32_16x16x32_bf16 v[248:251], a[144:147], v[76:79], v[248:251]
    v_mfma_f32_16x16x32_bf16 v[252:255], a[148:151], v[76:79], v[252:255]
    v_mfma_f32_16x16x32_bf16 v[176:179], a[132:135], v[80:83], v[176:179]
    v_mfma_f32_16x16x32_bf16 v[180:183], a[136:139], v[80:83], v[180:183]
    v_mfma_f32_16x16x32_bf16 v[184:187], a[140:143], v[80:83], v[184:187]
    v_mfma_f32_16x16x32_bf16 v[188:191], a[144:147], v[80:83], v[188:191]
    v_mfma_f32_16x16x32_bf16 v[192:195], a[148:151], v[80:83], v[192:195]
    s_waitcnt vmcnt(8)
    v_mfma_f32_16x16x32_bf16 v[196:199], a[152:155], a[52:55], v[196:199]
    v_mfma_f32_16x16x32_bf16 v[200:203], a[156:159], a[52:55], v[200:203]
    v_mfma_f32_16x16x32_bf16 v[204:207], a[160:163], a[52:55], v[204:207]
    v_mfma_f32_16x16x32_bf16 v[208:211], a[164:167], a[52:55], v[208:211]
    v_mfma_f32_16x16x32_bf16 v[212:215], a[168:171], a[52:55], v[212:215]
    v_mfma_f32_16x16x32_bf16 v[216:219], a[152:155], a[56:59], v[216:219]
    v_mfma_f32_16x16x32_bf16 v[220:223], a[156:159], a[56:59], v[220:223]
    v_mfma_f32_16x16x32_bf16 v[224:227], a[160:163], a[56:59], v[224:227]
    v_mfma_f32_16x16x32_bf16 v[228:231], a[164:167], a[56:59], v[228:231]
    v_mfma_f32_16x16x32_bf16 v[232:235], a[168:171], a[56:59], v[232:235]
    v_mfma_f32_16x16x32_bf16 v[236:239], a[152:155], a[60:63], v[236:239]
    v_mfma_f32_16x16x32_bf16 v[240:243], a[156:159], a[60:63], v[240:243]
    v_mfma_f32_16x16x32_bf16 v[244:247], a[160:163], a[60:63], v[244:247]
    v_mfma_f32_16x16x32_bf16 v[248:251], a[164:167], a[60:63], v[248:251]
    v_mfma_f32_16x16x32_bf16 v[252:255], a[168:171], a[60:63], v[252:255]
    v_mfma_f32_16x16x32_bf16 v[176:179], a[152:155], a[64:67], v[176:179]
    v_mfma_f32_16x16x32_bf16 v[180:183], a[156:159], a[64:67], v[180:183]
    v_mfma_f32_16x16x32_bf16 v[184:187], a[160:163], a[64:67], v[184:187]
    v_mfma_f32_16x16x32_bf16 v[188:191], a[164:167], a[64:67], v[188:191]
    v_mfma_f32_16x16x32_bf16 v[192:195], a[168:171], a[64:67], v[192:195]
    s_waitcnt vmcnt(4)
    v_mfma_f32_16x16x32_bf16 v[136:139], a[132:135], a[68:71], v[136:139]
    s_and_b32 s36, s26, 1024
    s_sub_u32 s36, s77, s36
    s_add_u32 s36, s36, 4096
    v_min_u32 v0, 240, v2
    v_lshlrev_b32 v0, 3, v0
    buffer_load_dwordx2 v[0:1], v0, s[4:7], s36 offen offset:0 sc1
    v_mfma_f32_16x16x32_bf16 v[140:143], a[136:139], a[68:71], v[140:143]
    v_mfma_f32_16x16x32_bf16 v[144:147], a[140:143], a[68:71], v[144:147]
    v_mfma_f32_16x16x32_bf16 v[148:151], a[144:147], a[68:71], v[148:151]
    v_mfma_f32_16x16x32_bf16 v[152:155], a[148:151], a[68:71], v[152:155]
    v_mfma_f32_16x16x32_bf16 v[116:119], a[132:135], a[72:75], v[116:119]
    v_mfma_f32_16x16x32_bf16 v[120:123], a[136:139], a[72:75], v[120:123]
    v_mfma_f32_16x16x32_bf16 v[124:127], a[140:143], a[72:75], v[124:127]
    v_mfma_f32_16x16x32_bf16 v[128:131], a[144:147], a[72:75], v[128:131]
    v_mfma_f32_16x16x32_bf16 v[132:135], a[148:151], a[72:75], v[132:135]
    v_mfma_f32_16x16x32_bf16 v[96:99], a[132:135], a[76:79], v[96:99]
    v_mfma_f32_16x16x32_bf16 v[100:103], a[136:139], a[76:79], v[100:103]
    v_mfma_f32_16x16x32_bf16 v[104:107], a[140:143], a[76:79], v[104:107]
    v_mfma_f32_16x16x32_bf16 v[108:111], a[144:147], a[76:79], v[108:111]
    v_mfma_f32_16x16x32_bf16 v[112:115], a[148:151], a[76:79], v[112:115]
    v_mfma_f32_16x16x32_bf16 v[156:159], a[132:135], a[80:83], v[156:159]
    v_mfma_f32_16x16x32_bf16 v[160:163], a[136:139], a[80:83], v[160:163]
    v_mfma_f32_16x16x32_bf16 v[164:167], a[140:143], a[80:83], v[164:167]
    v_mfma_f32_16x16x32_bf16 v[168:171], a[144:147], a[80:83], v[168:171]
    v_mfma_f32_16x16x32_bf16 v[172:175], a[148:151], a[80:83], v[172:175]
    s_waitcnt vmcnt(1)
    v_mfma_f32_16x16x32_bf16 v[136:139], a[152:155], v[48:51], v[136:139]
    s_waitcnt vmcnt(0)
    v_cmp_ne_u64 vcc, s[58:59], v[0:1]
    s_nop 0
    s_cbranch_vccnz L_p8_retry
L_p8_ok:
    v_mfma_f32_16x16x32_bf16 v[140:143], a[156:159], v[48:51], v[140:143]
    s_add_u32 s16, s72, 65536
    s_add_u32 s17, s73, 65536
    v_mfma_f32_16x16x32_bf16 v[144:147], a[160:163], v[48:51], v[144:147]
    s_add_u32 s18, s72, 131072
    s_add_u32 s19, s73, 131072
    v_mfma_f32_16x16x32_bf16 v[148:151], a[164:167], v[48:51], v[148:151]
    buffer_load_dwordx4 v[16:19], v90, s[4:7], s76 offen sc1
    v_mfma_f32_16x16x32_bf16 v[152:155], a[168:171], v[48:51], v[152:155]
    buffer_load_dwordx4 v[20:23], v88, s[4:7], s76 offen sc1
    v_mfma_f32_16x16x32_bf16 v[116:119], a[152:155], v[52:55], v[116:119]
    buffer_load_dwordx4 v[32:35], v89, s[4:7], s16 offen sc1
    v_mfma_f32_16x16x32_bf16 v[120:123], a[156:159], v[52:55], v[120:123]
    buffer_load_dwordx4 v[36:39], v89, s[4:7], s17 offen sc1
    v_mfma_f32_16x16x32_bf16 v[124:127], a[160:163], v[52:55], v[124:127]
    buffer_load_dwordx4 v[40:43], v89, s[4:7], s18 offen sc1
    v_mfma_f32_16x16x32_bf16 v[128:131], a[164:167], v[52:55], v[128:131]
    buffer_load_dwordx4 v[44:47], v89, s[4:7], s19 offen sc1
    v_mfma_f32_16x16x32_bf16 v[132:135], a[168:171], v[52:55], v[132:135]
    buffer_load_dwordx4 a[0:3], v90, s[4:7], s16 offen sc1
    v_mfma_f32_16x16x32_bf16 v[96:99], a[152:155], v[56:59], v[96:99]
    buffer_load_dwordx4 a[4:7], v90, s[4:7], s17 offen sc1
    v_mfma_f32_16x16x32_bf16 v[100:103], a[156:159], v[56:59], v[100:103]
    buffer_load_dwordx4 a[8:11], v90, s[4:7], s18 offen sc1
    v_mfma_f32_16x16x32_bf16 v[104:107], a[160:163], v[56:59], v[104:107]
    buffer_load_dwordx4 a[12:15], v90, s[4:7], s19 offen sc1
    v_mfma_f32_16x16x32_bf16 v[108:111], a[164:167], v[56:59], v[108:111]
    v_mfma_f32_16x16x32_bf16 v[112:115], a[168:171], v[56:59], v[112:115]
    v_mfma_f32_16x16x32_bf16 v[156:159], a[152:155], v[60:63], v[156:159]
    v_mfma_f32_16x16x32_bf16 v[160:163], a[156:159], v[60:63], v[160:163]
    v_mfma_f32_16x16x32_bf16 v[164:167], a[160:163], v[60:63], v[164:167]
    v_mfma_f32_16x16x32_bf16 v[168:171], a[164:167], v[60:63], v[168:171]
    v_mfma_f32_16x16x32_bf16 v[172:175], a[168:171], v[60:63], v[172:175]
    s_waitcnt vmcnt(8)
    v_mfma_f32_16x16x32_bf16 v[216:219], a[32:35], v[16:19], v[216:219]
    buffer_load_dwordx4 a[16:19], v91, s[4:7], s16 offen sc1
    v_mfma_f32_16x16x32_bf16 v[220:223], a[36:39], v[16:19], v[220:223]
    buffer_load_dwordx4 a[20:23], v91, s[4:7], s17 offen sc1
    v_mfma_f32_16x16x32_bf16 v[224:227], a[40:43], v[16:19], v[224:227]
    buffer_load_dwordx4 a[24:27], v91, s[4:7], s18 offen sc1
    v_mfma_f32_16x16x32_bf16 v[228:231], a[44:47], v[16:19], v[228:231]
    buffer_load_dwordx4 a[28:31], v91, s[4:7], s19 offen sc1
    v_mfma_f32_16x16x32_bf16 v[232:235], a[48:51], v[16:19], v[232:235]
    s_add_u32 s61, s54, 1
    s_and_b32 s61, s61, 3
    v_mfma_f32_16x16x32_bf16 v[176:179], a[32:35], v[20:23], v[176:179]
    s_mul_i32 s61, s61, 15360
    s_add_u32 s61, s61, 0
    v_mfma_f32_16x16x32_bf16 v[180:183], a[36:39], v[20:23], v[180:183]
    v_add_u32 v8, s61, v2
    s_add_u32 s61, s54, 2
    v_mfma_f32_16x16x32_bf16 v[184:187], a[40:43], v[20:23], v[184:187]
    s_and_b32 s61, s61, 3
    s_mul_i32 s61, s61, 15360
    v_mfma_f32_16x16x32_bf16 v[188:191], a[44:47], v[20:23], v[188:191]
    s_add_u32 s61, s61, 0
    v_add_u32 v9, s61, v2
    v_mfma_f32_16x16x32_bf16 v[192:195], a[48:51], v[20:23], v[192:195]
    s_add_u32 s61, s54, 3
    s_and_b32 s61, s61, 3
    s_waitcnt vmcnt(8)
    v_mfma_f32_16x16x32_bf16 v[196:199], a[172:175], v[32:35], v[196:199]
    buffer_load_dwordx4 v[68:71], v88, s[4:7], s16 offen sc1
    v_mfma_f32_16x16x32_bf16 v[200:203], a[176:179], v[32:35], v[200:203]
    buffer_load_dwordx4 v[72:75], v88, s[4:7], s17 offen sc1
    v_mfma_f32_16x16x32_bf16 v[204:207], a[180:183], v[32:35], v[204:207]
    buffer_load_dwordx4 v[76:79], v88, s[4:7], s18 offen sc1
    v_mfma_f32_16x16x32_bf16 v[208:211], a[184:187], v[32:35], v[208:211]
    buffer_load_dwordx4 v[80:83], v88, s[4:7], s19 offen sc1
    v_mfma_f32_16x16x32_bf16 v[212:215], a[188:191], v[32:35], v[212:215]
    s_mul_i32 s61, s61, 15360
    s_add_u32 s61, s61, 0
    v_mfma_f32_16x16x32_bf16 v[196:199], a[192:195], v[36:39], v[196:199]
    v_add_u32 v10, s61, v2
    s_mul_i32 s61, s54, 15360
    v_mfma_f32_16x16x32_bf16 v[200:203], a[196:199], v[36:39], v[200:203]
    s_add_u32 s61, s61, 0
    v_add_u32 v92, s61, v2
    v_mfma_f32_16x16x32_bf16 v[204:207], a[200:203], v[36:39], v[204:207]
    v_mfma_f32_16x16x32_bf16 v[208:211], a[204:207], v[36:39], v[208:211]
    v_mfma_f32_16x16x32_bf16 v[212:215], a[208:211], v[36:39], v[212:215]
    v_mfma_f32_16x16x32_bf16 v[196:199], a[212:215], v[40:43], v[196:199]
    v_mfma_f32_16x16x32_bf16 v[200:203], a[216:219], v[40:43], v[200:203]
    v_mfma_f32_16x16x32_bf16 v[204:207], a[220:223], v[40:43], v[204:207]
    v_mfma_f32_16x16x32_bf16 v[208:211], a[224:227], v[40:43], v[208:211]
    v_mfma_f32_16x16x32_bf16 v[212:215], a[228:231], v[40:43], v[212:215]
    v_mfma_f32_16x16x32_bf16 v[196:199], a[232:235], v[44:47], v[196:199]
    v_mfma_f32_16x16x32_bf16 v[200:203], a[236:239], v[44:47], v[200:203]
    v_mfma_f32_16x16x32_bf16 v[204:207], a[240:243], v[44:47], v[204:207]
    v_mfma_f32_16x16x32_bf16 v[208:211], a[244:247], v[44:47], v[208:211]
    v_mfma_f32_16x16x32_bf16 v[212:215], a[248:251], v[44:47], v[212:215]
    s_waitcnt vmcnt(8)
    v_mfma_f32_16x16x32_bf16 v[216:219], a[172:175], a[0:3], v[216:219]
    s_add_u32 s16, s74, 65536
    s_add_u32 s17, s75, 65536
    v_mfma_f32_16x16x32_bf16 v[220:223], a[176:179], a[0:3], v[220:223]
    s_add_u32 s18, s74, 131072
    s_add_u32 s19, s75, 131072
    v_mfma_f32_16x16x32_bf16 v[224:227], a[180:183], a[0:3], v[224:227]
    buffer_load_dwordx4 a[52:55], v90, s[4:7], s78 offen sc1
    v_mfma_f32_16x16x32_bf16 v[228:231], a[184:187], a[0:3], v[228:231]
    buffer_load_dwordx4 a[56:59], v88, s[4:7], s78 offen sc1
    v_mfma_f32_16x16x32_bf16 v[232:235], a[188:191], a[0:3], v[232:235]
    ds_write_b128 v8, v[196:199] offset:0
    v_mfma_f32_16x16x32_bf16 v[216:219], a[192:195], a[4:7], v[216:219]
    ds_write_b128 v8, v[200:203] offset:1024
    v_mfma_f32_16x16x32_bf16 v[220:223], a[196:199], a[4:7], v[220:223]
    ds_write_b128 v8, v[204:207] offset:2048
    v_mfma_f32_16x16x32_bf16 v[224:227], a[200:203], a[4:7], v[224:227]
    ds_write_b128 v8, v[208:211] offset:3072
    v_mfma_f32_16x16x32_bf16 v[228:231], a[204:207], a[4:7], v[228:231]
    ds_write_b128 v8, v[212:215] offset:4096
    v_mfma_f32_16x16x32_bf16 v[232:235], a[208:211], a[4:7], v[232:235]
    v_mfma_f32_16x16x32_bf16 v[216:219], a[212:215], a[8:11], v[216:219]
    v_mfma_f32_16x16x32_bf16 v[220:223], a[216:219], a[8:11], v[220:223]
    v_mfma_f32_16x16x32_bf16 v[224:227], a[220:223], a[8:11], v[224:227]
    v_mfma_f32_16x16x32_bf16 v[228:231], a[224:227], a[8:11], v[228:231]
    v_mfma_f32_16x16x32_bf16 v[232:235], a[228:231], a[8:11], v[232:235]
    v_mfma_f32_16x16x32_bf16 v[216:219], a[232:235], a[12:15], v[216:219]
    v_mfma_f32_16x16x32_bf16 v[220:223], a[236:239], a[12:15], v[220:223]
    v_mfma_f32_16x16x32_bf16 v[224:227], a[240:243], a[12:15], v[224:227]
    v_mfma_f32_16x16x32_bf16 v[228:231], a[244:247], a[12:15], v[228:231]
    v_mfma_f32_16x16x32_bf16 v[232:235], a[248:251], a[12:15], v[232:235]
    s_waitcnt vmcnt(6)
    v_mfma_f32_16x16x32_bf16 v[236:239], a[172:175], a[16:19], v[236:239]
    buffer_load_dwordx4 a[68:71], v89, s[4:7], s16 offen sc1
    v_mfma_f32_16x16x32_bf16 v[240:243], a[176:179], a[16:19], v[240:243]
    buffer_load_dwordx4 a[72:75], v89, s[4:7], s17 offen sc1
    v_mfma_f32_16x16x32_bf16 v[244:247], a[180:183], a[16:19], v[244:247]
    buffer_load_dwordx4 a[76:79], v89, s[4:7], s18 offen sc1
    v_mfma_f32_16x16x32_bf16 v[248:251], a[184:187], a[16:19], v[248:251]
    buffer_load_dwordx4 a[80:83], v89, s[4:7], s19 offen sc1
    v_mfma_f32_16x16x32_bf16 v[252:255], a[188:191], a[16:19], v[252:255]
    ds_write_b128 v9, v[216:219] offset:5120
    v_mfma_f32_16x16x32_bf16 v[236:239], a[192:195], a[20:23], v[236:239]
    ds_write_b128 v9, v[220:223] offset:6144
    v_mfma_f32_16x16x32_bf16 v[240:243], a[196:199], a[20:23], v[240:243]
    ds_write_b128 v9, v[224:227] offset:7168
    v_mfma_f32_16x16x32_bf16 v[244:247], a[200:203], a[20:23], v[244:247]
    ds_write_b128 v9, v[228:231] offset:8192
    v_mfma_f32_16x16x32_bf16 v[248:251], a[204:207], a[20:23], v[248:251]
    ds_write_b128 v9, v[232:235] offset:9216
    v_mfma_f32_16x16x32_bf16 v[252:255], a[208:211], a[20:23], v[252:255]
    v_mfma_f32_16x16x32_bf16 v[236:239], a[212:215], a[24:27], v[236:239]
    v_mfma_f32_16x16x32_bf16 v[240:243], a[216:219], a[24:27], v[240:243]
    v_mfma_f32_16x16x32_bf16 v[244:247], a[220:223], a[24:27], v[244:247]
    v_mfma_f32_16x16x32_bf16 v[248:251], a[224:227], a[24:27], v[248:251]
    v_mfma_f32_16x16x32_bf16 v[252:255], a[228:231], a[24:27], v[252:255]
    v_mfma_f32_16x16x32_bf16 v[236:239], a[232:235], a[28:31], v[236:239]
    v_mfma_f32_16x16x32_bf16 v[240:243], a[236:239], a[28:31], v[240:243]
    v_mfma_f32_16x16x32_bf16 v[244:247], a[240:243], a[28:31], v[244:247]
    v_mfma_f32_16x16x32_bf16 v[248:251], a[244:247], a[28:31], v[248:251]
    v_mfma_f32_16x16x32_bf16 v[252:255], a[248:251], a[28:31], v[252:255]
    s_waitcnt vmcnt(6)
    v_mfma_f32_16x16x32_bf16 v[176:179], a[172:175], v[68:71], v[176:179]
    buffer_load_dwordx4 v[48:51], v90, s[4:7], s16 offen sc1
    v_mfma_f32_16x16x32_bf16 v[180:183], a[176:179], v[68:71], v[180:183]
    buffer_load_dwordx4 v[52:55], v90, s[4:7], s17 offen sc1
    v_mfma_f32_16x16x32_bf16 v[184:187], a[180:183], v[68:71], v[184:187]
    buffer_load_dwordx4 v[56:59], v90, s[4:7], s18 offen sc1
    v_mfma_f32_16x16x32_bf16 v[188:191], a[184:187], v[68:71], v[188:191]
    buffer_load_dwordx4 v[60:63], v90, s[4:7], s19 offen sc1
    v_mfma_f32_16x16x32_bf16 v[192:195], a[188:191], v[68:71], v[192:195]
    ds_write_b128 v10, v[236:239] offset:10240
    v_mfma_f32_16x16x32_bf16 v[176:179], a[192:195], v[72:75], v[176:179]
    ds_write_b128 v10, v[240:243] offset:11264
    v_mfma_f32_16x16x32_bf16 v[180:183], a[196:199], v[72:75], v[180:183]
    ds_write_b128 v10, v[244:247] offset:12288
    v_mfma_f32_16x16x32_bf16 v[184:187], a[200:203], v[72:75], v[184:187]
    ds_write_b128 v10, v[248:251] offset:13312
    v_mfma_f32_16x16x32_bf16 v[188:191], a[204:207], v[72:75], v[188:191]
    ds_write_b128 v10, v[252:255] offset:14336
    v_mfma_f32_16x16x32_bf16 v[192:195], a[208:211], v[72:75], v[192:195]
    s_waitcnt lgkmcnt(0)
    s_barrier
    v_mfma_f32_16x16x32_bf16 v[176:179], a[212:215], v[76:79], v[176:179]
    ds_read_b128 v[196:199], v92 offset:0
    ds_read_b128 v[200:203], v92 offset:1024
    v_mfma_f32_16x16x32_bf16 v[180:183], a[216:219], v[76:79], v[180:183]
    ds_read_b128 v[204:207], v92 offset:2048
    ds_read_b128 v[208:211], v92 offset:3072
    v_mfma_f32_16x16x32_bf16 v[184:187], a[220:223], v[76:79], v[184:187]
    ds_read_b128 v[212:215], v92 offset:4096
    ds_read_b128 v[216:219], v92 offset:5120
    v_mfma_f32_16x16x32_bf16 v[188:191], a[224:227], v[76:79], v[188:191]
    ds_read_b128 v[220:223], v92 offset:6144
    ds_read_b128 v[224:227], v92 offset:7168
    v_mfma_f32_16x16x32_bf16 v[192:195], a[228:231], v[76:79], v[192:195]
    ds_read_b128 v[228:231], v92 offset:8192
    ds_read_b128 v[232:235], v92 offset:9216
    v_mfma_f32_16x16x32_bf16 v[176:179], a[232:235], v[80:83], v[176:179]
    ds_read_b128 v[236:239], v92 offset:10240
    ds_read_b128 v[240:243], v92 offset:11264
    v_mfma_f32_16x16x32_bf16 v[180:183], a[236:239], v[80:83], v[180:183]
    ds_read_b128 v[244:247], v92 offset:12288
    ds_read_b128 v[248:251], v92 offset:13312
    v_mfma_f32_16x16x32_bf16 v[184:187], a[240:243], v[80:83], v[184:187]
    ds_read_b128 v[252:255], v92 offset:14336
    v_mfma_f32_16x16x32_bf16 v[188:191], a[244:247], v[80:83], v[188:191]
    v_mfma_f32_16x16x32_bf16 v[192:195], a[248:251], v[80:83], v[192:195]
    s_waitcnt vmcnt(8)
    v_mfma_f32_16x16x32_bf16 v[116:119], a[32:35], a[52:55], v[116:119]
    buffer_load_dwordx4 v[16:19], v91, s[4:7], s16 offen sc1
    v_mfma_f32_16x16x32_bf16 v[120:123], a[36:39], a[52:55], v[120:123]
    buffer_load_dwordx4 v[20:23], v91, s[4:7], s17 offen sc1
    v_mfma_f32_16x16x32_bf16 v[124:127], a[40:43], a[52:55], v[124:127]
    buffer_load_dwordx4 v[24:27], v91, s[4:7], s18 offen sc1
    v_mfma_f32_16x16x32_bf16 v[128:131], a[44:47], a[52:55], v[128:131]
    buffer_load_dwordx4 v[28:31], v91, s[4:7], s19 offen sc1
    v_mfma_f32_16x16x32_bf16 v[132:135], a[48:51], a[52:55], v[132:135]
    s_waitcnt lgkmcnt(12)
    v_add_f32 v176, v176, v196
    v_mfma_f32_16x16x32_bf16 v[156:159], a[32:35], a[56:59], v[156:159]
    v_add_f32 v177, v177, v197
    v_add_f32 v178, v178, v198
    v_mfma_f32_16x16x32_bf16 v[160:163], a[36:39], a[56:59], v[160:163]
    v_add_f32 v179, v179, v199
    v_add_f32 v180, v180, v200
    v_mfma_f32_16x16x32_bf16 v[164:167], a[40:43], a[56:59], v[164:167]
    v_add_f32 v181, v181, v201
    v_add_f32 v182, v182, v202
    v_mfma_f32_16x16x32_bf16 v[168:171], a[44:47], a[56:59], v[168:171]
    v_add_f32 v183, v183, v203
    v_add_f32 v184, v184, v204
    v_mfma_f32_16x16x32_bf16 v[172:175], a[48:51], a[56:59], v[172:175]
    v_add_f32 v185, v185, v205
    v_add_f32 v186, v186, v206
    s_waitcnt vmcnt(8)
    v_mfma_f32_16x16x32_bf16 v[136:139], a[172:175], a[68:71], v[136:139]
    buffer_load_dwordx4 v[32:35], v88, s[4:7], s16 offen sc1
    v_mfma_f32_16x16x32_bf16 v[140:143], a[176:179], a[68:71], v[140:143]
    buffer_load_dwordx4 v[36:39], v88, s[4:7], s17 offen sc1
    v_mfma_f32_16x16x32_bf16 v[144:147], a[180:183], a[68:71], v[144:147]
    buffer_load_dwordx4 v[40:43], v88, s[4:7], s18 offen sc1
    v_mfma_f32_16x16x32_bf16 v[148:151], a[184:187], a[68:71], v[148:151]
    buffer_load_dwordx4 v[44:47], v88, s[4:7], s19 offen sc1
    v_mfma_f32_16x16x32_bf16 v[152:155], a[188:191], a[68:71], v[152:155]
    v_add_f32 v187, v187, v207
    s_waitcnt lgkmcnt(9)
    v_mfma_f32_16x16x32_bf16 v[136:139], a[192:195], a[72:75], v[136:139]
    v_add_f32 v188, v188, v208
    v_add_f32 v189, v189, v209
    v_mfma_f32_16x16x32_bf16 v[140:143], a[196:199], a[72:75], v[140:143]
    v_add_f32 v190, v190, v210
    v_add_f32 v191, v191, v211
    v_mfma_f32_16x16x32_bf16 v[144:147], a[200:203], a[72:75], v[144:147]
    v_add_f32 v192, v192, v212
    v_add_f32 v193, v193, v213
    v_mfma_f32_16x16x32_bf16 v[148:151], a[204:207], a[72:75], v[148:151]
    v_add_f32 v194, v194, v214
    v_add_f32 v195, v195, v215
    v_mfma_f32_16x16x32_bf16 v[152:155], a[208:211], a[72:75], v[152:155]
    v_add_f32 v176, v176, v216
    v_add_f32 v177, v177, v217
    v_mfma_f32_16x16x32_bf16 v[136:139], a[212:215], a[76:79], v[136:139]
    v_add_f32 v178, v178, v218
    v_add_f32 v179, v179, v219
    v_mfma_f32_16x16x32_bf16 v[140:143], a[216:219], a[76:79], v[140:143]
    s_waitcnt lgkmcnt(6)
    v_add_f32 v180, v180, v220
    v_mfma_f32_16x16x32_bf16 v[144:147], a[220:223], a[76:79], v[144:147]
    v_add_f32 v181, v181, v221
    v_add_f32 v182, v182, v222
    v_mfma_f32_16x16x32_bf16 v[148:151], a[224:227], a[76:79], v[148:151]
    v_add_f32 v183, v183, v223
    v_add_f32 v184, v184, v224
    v_mfma_f32_16x16x32_bf16 v[152:155], a[228:231], a[76:79], v[152:155]
    v_add_f32 v185, v185, v225
    v_add_f32 v186, v186, v226
    v_mfma_f32_16x16x32_bf16 v[136:139], a[232:235], a[80:83], v[136:139]
    v_add_f32 v187, v187, v227
    v_add_f32 v188, v188, v228
    v_mfma_f32_16x16x32_bf16 v[140:143], a[236:239], a[80:83], v[140:143]
    v_add_f32 v189, v189, v229
    v_add_f32 v190, v190, v230
    v_mfma_f32_16x16x32_bf16 v[144:147], a[240:243], a[80:83], v[144:147]
    v_add_f32 v191, v191, v231
    s_waitcnt lgkmcnt(3)
    v_mfma_f32_16x16x32_bf16 v[148:151], a[244:247], a[80:83], v[148:151]
    v_add_f32 v192, v192, v232
    v_add_f32 v193, v193, v233
    v_mfma_f32_16x16x32_bf16 v[152:155], a[248:251], a[80:83], v[152:155]
    v_add_f32 v194, v194, v234
    v_add_f32 v195, v195, v235
    v_add_f32 v176, v176, v236
    v_add_f32 v177, v177, v237
    v_add_f32 v178, v178, v238
    v_add_f32 v179, v179, v239
    v_add_f32 v180, v180, v240
    v_add_f32 v181, v181, v241
    v_add_f32 v182, v182, v242
    v_add_f32 v183, v183, v243
    s_waitcnt lgkmcnt(0)
    v_add_f32 v184, v184, v244
    v_add_f32 v185, v185, v245
    v_add_f32 v186, v186, v246
    v_add_f32 v187, v187, v247
    v_add_f32 v188, v188, v248
    v_add_f32 v189, v189, v249
    v_add_f32 v190, v190, v250
    v_add_f32 v191, v191, v251
    v_add_f32 v192, v192, v252
    v_add_f32 v193, v193, v253
    v_add_f32 v194, v194, v254
    v_add_f32 v195, v195, v255
    v_cvt_pk_bf16_f32 v196, v176, v177
    v_cvt_pk_bf16_f32 v197, v178, v179
    v_cvt_pk_bf16_f32 v198, v180, v181
    v_cvt_pk_bf16_f32 v200, v182, v183
    v_cvt_pk_bf16_f32 v201, v184, v185
    v_cvt_pk_bf16_f32 v202, v186, v187
    v_cvt_pk_bf16_f32 v204, v188, v189
    v_cvt_pk_bf16_f32 v205, v190, v191
    v_cvt_pk_bf16_f32 v206, v192, v193
    v_cvt_pk_bf16_f32 v208, v194, v195
    v_mov_b32 v199, s58
    v_mov_b32 v203, s58
    v_mov_b32 v207, s58
    v_mov_b32 v209, s58
    buffer_store_dwordx4 v[196:199], v2, s[4:7], s29 offen offset:0 sc1
    buffer_store_dwordx4 v[200:203], v2, s[4:7], s29 offen offset:1024 sc1
    buffer_store_dwordx4 v[204:207], v2, s[4:7], s29 offen offset:2048 sc1
    buffer_store_dwordx4 v[208:211], v2, s[4:7], s29 offen offset:3072 sc1
    s_waitcnt vmcnt(12)
    v_mfma_f32_16x16x32_bf16 v[116:119], a[172:175], v[48:51], v[116:119]
    s_add_u32 s61, s54, 1
    s_and_b32 s61, s61, 3
    v_mfma_f32_16x16x32_bf16 v[120:123], a[176:179], v[48:51], v[120:123]
    s_mul_i32 s61, s61, 15360
    s_add_u32 s61, s61, 65536
    v_mfma_f32_16x16x32_bf16 v[124:127], a[180:183], v[48:51], v[124:127]
    v_add_u32 v8, s61, v2
    s_add_u32 s61, s54, 2
    v_mfma_f32_16x16x32_bf16 v[128:131], a[184:187], v[48:51], v[128:131]
    s_and_b32 s61, s61, 3
    s_mul_i32 s61, s61, 15360
    v_mfma_f32_16x16x32_bf16 v[132:135], a[188:191], v[48:51], v[132:135]
    s_add_u32 s61, s61, 65536
    v_add_u32 v9, s61, v2
    v_mfma_f32_16x16x32_bf16 v[116:119], a[192:195], v[52:55], v[116:119]
    s_add_u32 s61, s54, 3
    s_and_b32 s61, s61, 3
    v_mfma_f32_16x16x32_bf16 v[120:123], a[196:199], v[52:55], v[120:123]
    s_mul_i32 s61, s61, 15360
    s_add_u32 s61, s61, 65536
    v_mfma_f32_16x16x32_bf16 v[124:127], a[200:203], v[52:55], v[124:127]
    v_add_u32 v10, s61, v2
    s_mul_i32 s61, s54, 15360
    v_mfma_f32_16x16x32_bf16 v[128:131], a[204:207], v[52:55], v[128:131]
    s_add_u32 s61, s61, 65536
    v_add_u32 v93, s61, v2
    v_mfma_f32_16x16x32_bf16 v[132:135], a[208:211], v[52:55], v[132:135]
    ds_write_b128 v8, v[136:139] offset:0
    v_mfma_f32_16x16x32_bf16 v[116:119], a[212:215], v[56:59], v[116:119]
    ds_write_b128 v8, v[140:143] offset:1024
    v_mfma_f32_16x16x32_bf16 v[120:123], a[216:219], v[56:59], v[120:123]
    ds_write_b128 v8, v[144:147] offset:2048
    v_mfma_f32_16x16x32_bf16 v[124:127], a[220:223], v[56:59], v[124:127]
    ds_write_b128 v8, v[148:151] offset:3072
    v_mfma_f32_16x16x32_bf16 v[128:131], a[224:227], v[56:59], v[128:131]
    ds_write_b128 v8, v[152:155] offset:4096
    v_mfma_f32_16x16x32_bf16 v[132:135], a[228:231], v[56:59], v[132:135]
    v_mfma_f32_16x16x32_bf16 v[116:119], a[232:235], v[60:63], v[116:119]
    v_mfma_f32_16x16x32_bf16 v[120:123], a[236:239], v[60:63], v[120:123]
    v_mfma_f32_16x16x32_bf16 v[124:127], a[240:243], v[60:63], v[124:127]
    v_mfma_f32_16x16x32_bf16 v[128:131], a[244:247], v[60:63], v[128:131]
    v_mfma_f32_16x16x32_bf16 v[132:135], a[248:251], v[60:63], v[132:135]
    s_waitcnt vmcnt(8)
    v_mfma_f32_16x16x32_bf16 v[96:99], a[172:175], v[16:19], v[96:99]
    v_mfma_f32_16x16x32_bf16 v[100:103], a[176:179], v[16:19], v[100:103]
    v_mfma_f32_16x16x32_bf16 v[104:107], a[180:183], v[16:19], v[104:107]
    ds_write_b128 v9, v[116:119] offset:5120
    v_mfma_f32_16x16x32_bf16 v[108:111], a[184:187], v[16:19], v[108:111]
    ds_write_b128 v9, v[120:123] offset:6144
    v_mfma_f32_16x16x32_bf16 v[112:115], a[188:191], v[16:19], v[112:115]
    ds_write_b128 v9, v[124:127] offset:7168
    v_mfma_f32_16x16x32_bf16 v[96:99], a[192:195], v[20:23], v[96:99]
    ds_write_b128 v9, v[128:131] offset:8192
    v_mfma_f32_16x16x32_bf16 v[100:103], a[196:199], v[20:23], v[100:103]
    ds_write_b128 v9, v[132:135] offset:9216
    v_mfma_f32_16x16x32_bf16 v[104:107], a[200:203], v[20:23], v[104:107]
    v_mfma_f32_16x16x32_bf16 v[108:111], a[204:207], v[20:23], v[108:111]
    v_mfma_f32_16x16x32_bf16 v[112:115], a[208:211], v[20:23], v[112:115]
    v_mfma_f32_16x16x32_bf16 v[96:99], a[212:215], v[24:27], v[96:99]
    v_mfma_f32_16x16x32_bf16 v[100:103], a[216:219], v[24:27], v[100:103]
    v_mfma_f32_16x16x32_bf16 v[104:107], a[220:223], v[24:27], v[104:107]
    v_mfma_f32_16x16x32_bf16 v[108:111], a[224:227], v[24:27], v[108:111]
    v_mfma_f32_16x16x32_bf16 v[112:115], a[228:231], v[24:27], v[112:115]
    v_mfma_f32_16x16x32_bf16 v[96:99], a[232:235], v[28:31], v[96:99]
    v_mfma_f32_16x16x32_bf16 v[100:103], a[236:239], v[28:31], v[100:103]
    v_mfma_f32_16x16x32_bf16 v[104:107], a[240:243], v[28:31], v[104:107]
    v_mfma_f32_16x16x32_bf16 v[108:111], a[244:247], v[28:31], v[108:111]
    v_mfma_f32_16x16x32_bf16 v[112:115], a[248:251], v[28:31], v[112:115]
    buffer_load_dwordx4 v[216:219], v2, s[4:7], s81 offen offset:0 sc1
    buffer_load_dwordx4 v[220:223], v2, s[4:7], s81 offen offset:1024 sc1
    buffer_load_dwordx4 v[224:227], v2, s[4:7], s81 offen offset:2048 sc1
    buffer_load_dwordx2 v[228:229], v2, s[4:7], s81 offen offset:3072 sc1
    s_waitcnt vmcnt(8)
    v_mfma_f32_16x16x32_bf16 v[156:159], a[172:175], v[32:35], v[156:159]
    v_mfma_f32_16x16x32_bf16 v[160:163], a[176:179], v[32:35], v[160:163]
    v_mfma_f32_16x16x32_bf16 v[164:167], a[180:183], v[32:35], v[164:167]
    ds_write_b128 v10, v[96:99] offset:10240
    v_mfma_f32_16x16x32_bf16 v[168:171], a[184:187], v[32:35], v[168:171]
    ds_write_b128 v10, v[100:103] offset:11264
    v_mfma_f32_16x16x32_bf16 v[172:175], a[188:191], v[32:35], v[172:175]
    ds_write_b128 v10, v[104:107] offset:12288
    v_mfma_f32_16x16x32_bf16 v[156:159], a[192:195], v[36:39], v[156:159]
    ds_write_b128 v10, v[108:111] offset:13312
    v_mfma_f32_16x16x32_bf16 v[160:163], a[196:199], v[36:39], v[160:163]
    ds_write_b128 v10, v[112:115] offset:14336
    v_mfma_f32_16x16x32_bf16 v[164:167], a[200:203], v[36:39], v[164:167]
    s_waitcnt lgkmcnt(0)
    s_barrier
    v_mfma_f32_16x16x32_bf16 v[168:171], a[204:207], v[36:39], v[168:171]
    ds_read_b128 v[136:139], v93 offset:0
    ds_read_b128 v[140:143], v93 offset:1024
    v_mfma_f32_16x16x32_bf16 v[172:175], a[208:211], v[36:39], v[172:175]
    ds_read_b128 v[144:147], v93 offset:2048
    ds_read_b128 v[148:151], v93 offset:3072
    v_mfma_f32_16x16x32_bf16 v[156:159], a[212:215], v[40:43], v[156:159]
    ds_read_b128 v[152:155], v93 offset:4096
    ds_read_b128 v[116:119], v93 offset:5120
    v_mfma_f32_16x16x32_bf16 v[160:163], a[216:219], v[40:43], v[160:163]
    ds_read_b128 v[120:123], v93 offset:6144
    ds_read_b128 v[124:127], v93 offset:7168
    v_mfma_f32_16x16x32_bf16 v[164:167], a[220:223], v[40:43], v[164:167]
    ds_read_b128 v[128:131], v93 offset:8192
    ds_read_b128 v[132:135], v93 offset:9216
    v_mfma_f32_16x16x32_bf16 v[168:171], a[224:227], v[40:43], v[168:171]
    ds_read_b128 v[96:99], v93 offset:10240
    ds_read_b128 v[100:103], v93 offset:11264
    v_mfma_f32_16x16x32_bf16 v[172:175], a[228:231], v[40:43], v[172:175]
    ds_read_b128 v[104:107], v93 offset:12288
    ds_read_b128 v[108:111], v93 offset:13312
    v_mfma_f32_16x16x32_bf16 v[156:159], a[232:235], v[44:47], v[156:159]
    ds_read_b128 v[112:115], v93 offset:14336
    v_mfma_f32_16x16x32_bf16 v[160:163], a[236:239], v[44:47], v[160:163]
    v_mfma_f32_16x16x32_bf16 v[164:167], a[240:243], v[44:47], v[164:167]
    v_mfma_f32_16x16x32_bf16 v[168:171], a[244:247], v[44:47], v[168:171]
    v_mfma_f32_16x16x32_bf16 v[172:175], a[248:251], v[44:47], v[172:175]
    s_waitcnt lgkmcnt(12)
    s_nop 1
    v_pk_add_f32 v[156:157], v[156:157], v[136:137]
    v_pk_add_f32 v[158:159], v[158:159], v[138:139]
    v_pk_add_f32 v[160:161], v[160:161], v[140:141]
    v_pk_add_f32 v[162:163], v[162:163], v[142:143]
    v_pk_add_f32 v[164:165], v[164:165], v[144:145]
    v_pk_add_f32 v[166:167], v[166:167], v[146:147]
    s_waitcnt lgkmcnt(9)
    v_pk_add_f32 v[168:169], v[168:169], v[148:149]
    v_pk_add_f32 v[170:171], v[170:171], v[150:151]
    v_pk_add_f32 v[172:173], v[172:173], v[152:153]
    v_pk_add_f32 v[174:175], v[174:175], v[154:155]
    v_pk_add_f32 v[156:157], v[156:157], v[116:117]
    v_pk_add_f32 v[158:159], v[158:159], v[118:119]
    s_waitcnt lgkmcnt(6)
    v_pk_add_f32 v[160:161], v[160:161], v[120:121]
    v_pk_add_f32 v[162:163], v[162:163], v[122:123]
    v_pk_add_f32 v[164:165], v[164:165], v[124:125]
    v_pk_add_f32 v[166:167], v[166:167], v[126:127]
    v_pk_add_f32 v[168:169], v[168:169], v[128:129]
    v_pk_add_f32 v[170:171], v[170:171], v[130:131]
    s_waitcnt lgkmcnt(3)
    v_pk_add_f32 v[172:173], v[172:173], v[132:133]
    v_pk_add_f32 v[174:175], v[174:175], v[134:135]
    v_pk_add_f32 v[156:157], v[156:157], v[96:97]
    v_pk_add_f32 v[158:159], v[158:159], v[98:99]
    v_pk_add_f32 v[160:161], v[160:161], v[100:101]
    v_pk_add_f32 v[162:163], v[162:163], v[102:103]
    s_waitcnt lgkmcnt(0)
    v_pk_add_f32 v[164:165], v[164:165], v[104:105]
    v_pk_add_f32 v[166:167], v[166:167], v[106:107]
    v_pk_add_f32 v[168:169], v[168:169], v[108:109]
    v_pk_add_f32 v[170:171], v[170:171], v[110:111]
    v_pk_add_f32 v[172:173], v[172:173], v[112:113]
    v_pk_add_f32 v[174:175], v[174:175], v[114:115]
    s_waitcnt vmcnt(0)
    v_cmp_ne_u32 vcc, s58, v219
    v_cmp_ne_u32 s[62:63], s58, v223
    v_cmp_ne_u32 s[64:65], s58, v227
    v_cmp_ne_u32 s[66:67], s58, v229
    s_or_b64 vcc, vcc, s[62:63]
    s_or_b64 s[64:65], s[64:65], s[66:67]
    s_or_b64 vcc, vcc, s[64:65]
    s_cbranch_scc1 L_x_retry
L_x_ok:
    v_lshlrev_b32 v8, 16, v216
    v_and_b32 v9, 0xffff0000, v216
    v_pk_add_f32 v[8:9], v[8:9], v[156:157]
    v_cvt_pk_bf16_f32 v32, v8, v9
    v_lshlrev_b32 v8, 16, v217
    v_and_b32 v9, 0xffff0000, v217
    v_pk_add_f32 v[8:9], v[8:9], v[158:159]
    v_cvt_pk_bf16_f32 v33, v8, v9
    v_lshlrev_b32 v8, 16, v218
    v_and_b32 v9, 0xffff0000, v218
    v_pk_add_f32 v[8:9], v[8:9], v[160:161]
    v_cvt_pk_bf16_f32 v34, v8, v9
    v_lshlrev_b32 v8, 16, v220
    v_and_b32 v9, 0xffff0000, v220
    v_pk_add_f32 v[8:9], v[8:9], v[162:163]
    v_cvt_pk_bf16_f32 v35, v8, v9
    v_lshlrev_b32 v8, 16, v221
    v_and_b32 v9, 0xffff0000, v221
    v_pk_add_f32 v[8:9], v[8:9], v[164:165]
    v_cvt_pk_bf16_f32 v36, v8, v9
    v_lshlrev_b32 v8, 16, v222
    v_and_b32 v9, 0xffff0000, v222
    v_pk_add_f32 v[8:9], v[8:9], v[166:167]
    v_cvt_pk_bf16_f32 v37, v8, v9
    v_lshlrev_b32 v8, 16, v224
    v_and_b32 v9, 0xffff0000, v224
    v_pk_add_f32 v[8:9], v[8:9], v[168:169]
    v_cvt_pk_bf16_f32 v38, v8, v9
    v_lshlrev_b32 v8, 16, v225
    v_and_b32 v9, 0xffff0000, v225
    v_pk_add_f32 v[8:9], v[8:9], v[170:171]
    v_cvt_pk_bf16_f32 v39, v8, v9
    v_lshlrev_b32 v8, 16, v226
    v_and_b32 v9, 0xffff0000, v226
    v_pk_add_f32 v[8:9], v[8:9], v[172:173]
    v_cvt_pk_bf16_f32 v40, v8, v9
    v_lshlrev_b32 v8, 16, v228
    v_and_b32 v9, 0xffff0000, v228
    v_pk_add_f32 v[8:9], v[8:9], v[174:175]
    v_cvt_pk_bf16_f32 v41, v8, v9
    buffer_store_dwordx4 v[32:35], v15, s[40:43], s79 offen
    buffer_store_dwordx4 v[36:39], v15, s[40:43], s79 offen offset:16
    buffer_store_dwordx2 v[40:41], v15, s[40:43], s79 offen offset:32
    s_or_b32 s61, s2, s54
    s_cmp_lg_u32 s61, 0
    s_cbranch_scc1 L_nogen
    s_bfm_b64 exec, 8, 0
    buffer_store_dwordx4 a[252:255], v2, s[4:7], s61 offen sc1
    s_mov_b64 exec, -1
L_nogen:
L_end:
    s_endpgm
L_p1_retry:
    s_sub_u32 s57, s57, 1
    s_cmp_eq_u32 s57, 0
    s_cbranch_scc1 L_end2
    v_min_u32 v0, 144, v2
    v_lshlrev_b32 v0, 3, v0
    buffer_load_dwordx2 v[0:1], v0, s[4:7], s36 offen offset:0 sc1
    s_waitcnt vmcnt(0)
    v_cmp_ne_u64 vcc, s[58:59], v[0:1]
    s_nop 0
    s_cbranch_vccnz L_p1_retry
    s_nop 4
    s_branch L_p1_ok
L_p2_retry:
    s_sub_u32 s57, s57, 1
    s_cmp_eq_u32 s57, 0
    s_cbranch_scc1 L_end2
    v_min_u32 v0, 144, v2
    v_lshlrev_b32 v0, 3, v0
    buffer_load_dwordx2 v[0:1], v0, s[4:7], s36 offen offset:0 sc1
    s_waitcnt vmcnt(0)
    v_cmp_ne_u64 vcc, s[58:59], v[0:1]
    s_nop 0
    s_cbranch_vccnz L_p2_retry
    s_nop 4
    s_branch L_p2_ok
L_p3_retry:
    s_sub_u32 s57, s57, 1
    s_cmp_eq_u32 s57, 0
    s_cbranch_scc1 L_end2
    s_and_b32 s71, s37, 14
    v_lshrrev_b32 v90, 5, v2
    v_bfe_u32 v91, v2, 4, 1
    v_lshl_add_u32 v90, v90, 4, v91
    v_add_u32 v90, s71, v90
    s_lshr_b32 s71, s37, 2
    s_add_u32 s71, s71, 64
    v_min_u32 v90, s71, v90
    v_lshlrev_b32 v90, 7, v90
    buffer_load_dwordx2 v[90:91], v90, s[4:7], s36 offen offset:0 sc1
    s_waitcnt vmcnt(0)
    v_cmp_ne_u64 vcc, s[58:59], v[90:91]
    s_nop 0
    s_cbranch_vccnz L_p3_retry
    s_nop 4
    s_branch L_p3_ok
L_p4_retry:
    s_sub_u32 s57, s57, 1
    s_cmp_eq_u32 s57, 0
    s_cbranch_scc1 L_end2
    v_min_u32 v88, 144, v2
    v_lshlrev_b32 v88, 3, v88
    buffer_load_dwordx2 v[88:89], v88, s[4:7], s35 offen offset:0 sc1
    s_waitcnt vmcnt(0)
    v_cmp_ne_u64 vcc, s[58:59], v[88:89]
    s_nop 0
    s_cbranch_vccnz L_p4_retry
    s_nop 4
    s_branch L_p4_ok
L_p5_retry:
    s_sub_u32 s57, s57, 1
    s_cmp_eq_u32 s57, 0
    s_cbranch_scc1 L_end2
    v_min_u32 v0, 496, v2
    v_lshlrev_b32 v0, 3, v0
    buffer_load_dwordx2 v[0:1], v0, s[4:7], s39 offen offset:0 sc1
    s_waitcnt vmcnt(0)
    v_cmp_ne_u64 vcc, s[58:59], v[0:1]
    s_nop 0
    s_cbranch_vccnz L_p5_retry
    s_nop 4
    s_branch L_p5_ok
L_p6_retry:
    s_sub_u32 s57, s57, 1
    s_cmp_eq_u32 s57, 0
    s_cbranch_scc1 L_end2
    v_min_u32 v0, 112, v2
    v_lshlrev_b32 v0, 3, v0
    buffer_load_dwordx2 v[0:1], v0, s[4:7], s77 offen offset:0 sc1
    s_waitcnt vmcnt(0)
    v_cmp_ne_u64 vcc, s[58:59], v[0:1]
    s_nop 0
    s_cbranch_vccnz L_p6_retry
    s_nop 4
    s_branch L_p6_ok
L_p7_retry:
    s_sub_u32 s57, s57, 1
    s_cmp_eq_u32 s57, 0
    s_cbranch_scc1 L_end2
    v_min_u32 v0, 112, v2
    v_lshlrev_b32 v0, 3, v0
    buffer_load_dwordx2 v[0:1], v0, s[4:7], s77 offen offset:2048 sc1
    s_waitcnt vmcnt(0)
    v_cmp_ne_u64 vcc, s[58:59], v[0:1]
    s_nop 0
    s_cbranch_vccnz L_p7_retry
    s_nop 4
    s_branch L_p7_ok
L_p8_retry:
    s_sub_u32 s57, s57, 1
    s_cmp_eq_u32 s57, 0
    s_cbranch_scc1 L_end2
    v_min_u32 v0, 240, v2
    v_lshlrev_b32 v0, 3, v0
    buffer_load_dwordx2 v[0:1], v0, s[4:7], s36 offen offset:0 sc1
    s_waitcnt vmcnt(0)
    v_cmp_ne_u64 vcc, s[58:59], v[0:1]
    s_nop 0
    s_cbranch_vccnz L_p8_retry
    s_nop 4
    s_branch L_p8_ok
L_x_retry:
    s_sub_u32 s57, s57, 1
    s_cmp_eq_u32 s57, 0
    s_cbranch_scc1 L_end2
    buffer_load_dwordx4 v[216:219], v2, s[4:7], s81 offen offset:0 sc1
    buffer_load_dwordx4 v[220:223], v2, s[4:7], s81 offen offset:1024 sc1
    buffer_load_dwordx4 v[224:227], v2, s[4:7], s81 offen offset:2048 sc1
    buffer_load_dwordx2 v[228:229], v2, s[4:7], s81 offen offset:3072 sc1
    s_waitcnt vmcnt(0)
    v_cmp_ne_u32 vcc, s58, v219
    v_cmp_ne_u32 s[62:63], s58, v223
    v_cmp_ne_u32 s[64:65], s58, v227
    v_cmp_ne_u32 s[66:67], s58, v229
    s_or_b64 vcc, vcc, s[62:63]
    s_or_b64 s[64:65], s[64:65], s[66:67]
    s_or_b64 vcc, vcc, s[64:65]
    s_cbranch_scc1 L_x_retry
    s_nop 4
    s_branch L_x_ok
L_end2:
    s_endpgm
L_last:
.section .rodata,"a"
.p2align 6
.amdhsa_kernel parallel_sum__linear_kernel_hedgehog__dense_activation_squared_relu__prompt_kernel
  .amdhsa_next_free_vgpr 512
  .amdhsa_next_free_sgpr 102
  .amdhsa_accum_offset 256
  .amdhsa_group_segment_fixed_size 0
  .amdhsa_kernarg_size 96
  .amdhsa_user_sgpr_count 2
  .amdhsa_user_sgpr_kernarg_segment_ptr 1
  .amdhsa_system_sgpr_workgroup_id_x 1
.end_amdhsa_kernel
```
